```python
import torch

def _softmax(x, axis=-1):
    return torch.softmax(x, dim=axis)
def _gelu(x):
    return torch.nn.functional.gelu(x, approximate="tanh")
def _silu(x):
    return torch.nn.functional.silu(x)
def _sigmoid(x):
    return torch.sigmoid(x)
def _layernorm(x, axis=-1, eps=1e-5):
    m = x.mean(dim=axis, keepdim=True)
    v = x.var(dim=axis, keepdim=True, unbiased=False)
    return (x - m) / torch.sqrt(v + eps)
def _scatter_add(tgt, idx, src, axis=0):
    return tgt.clone().index_add_(axis, idx, src)
def _segment_sum(src, seg, n):
    out = torch.zeros((n,) + src.shape[1:], dtype=src.dtype)
    return out.index_add_(0, seg, src)
def _pad(x, pw):
    flat = tuple(v for pair in reversed(pw) for v in pair)
    return torch.nn.functional.pad(x, flat)

kernel_name = 'standalone__gqa_block_cached__near_ridge'

def setup_inputs():

    _w = (lambda a: (lambda t: t.to(torch.bfloat16) if t.is_floating_point() else t)(torch.as_tensor(a)))
    B, Sq, D = 16, 128, 640
    Hq, Hkv, Sk, Dh = 32, 32, 512, 128
    assert Hq % Hkv == 0, (Hq, Hkv)
    return {
        "x": _w((lambda *s: torch.randn(*s, dtype=torch.bfloat16) * 0.8)(B, Sq, D)),
        "k_cache": _w((lambda *s: torch.randn(*s, dtype=torch.bfloat16) * 0.8)(B, Hkv, Sk, Dh)),
        "v_cache": _w((lambda *s: torch.randn(*s, dtype=torch.bfloat16) * 0.05)(B, Hkv, Sk, Dh)),
        "wq": _w((lambda *s: torch.randn(*s, dtype=torch.bfloat16) * 0.8)(D, Hq * Dh) * (D ** -0.5)),
        "wo": _w((lambda *s: torch.randn(*s, dtype=torch.bfloat16) * 0.05)(Hq * Dh, D) * ((Hq * Dh) ** -0.5)),
    }

def reference(x, k_cache, v_cache, wq, wo):
    B, Sq, D = x.shape
    Hq, Dh = 32, 128
    Hkv = k_cache.shape[1]
    rep = Hq // Hkv
    q = (lambda x, *d: x.permute(*d))((x @ wq).reshape(B, Sq, Hq, Dh), 0, 2, 1, 3)
    k = (lambda x, n, axis: torch.repeat_interleave(x, n, dim=axis))(k_cache, rep, axis=1)
    v = (lambda x, n, axis: torch.repeat_interleave(x, n, dim=axis))(v_cache, rep, axis=1)
    scores = torch.einsum("bhqd,bhkd->bhqk", q, k) * (Dh ** -0.5)
    p = _softmax(scores, axis=-1)
    o = torch.einsum("bhqk,bhkd->bhqd", p, v)
    return (lambda x, *d: x.permute(*d))(o, 0, 2, 1, 3).reshape(B, Sq, Hq * Dh) @ wo
```

```asm
; @launch grid=(256,1,1) block=(512,1,1) lds=163840
.amdgcn_target "amdgcn-amd-amdhsa--gfx950"
.text
.globl standalone__gqa_block_cached__near_ridge_kernel
.p2align 8
.type standalone__gqa_block_cached__near_ridge_kernel,@function
standalone__gqa_block_cached__near_ridge_kernel:
    s_cmp_ge_u32 s2, 256
    s_cbranch_scc1 L_end
    s_load_dwordx16 s[4:19], s[0:1], 0
    v_lshrrev_b32 v244, 6, v0
    v_and_b32 v243, 63, v0
    v_readfirstlane_b32 s48, v244
    s_and_b32 s51, s2, 7
    s_lshr_b32 s101, s2, 3
    s_and_b32 s49, s51, 1
    s_lshl_b32 s49, s49, 3
    s_and_b32 s53, s101, 7
    s_add_u32 s49, s49, s53
    s_lshr_b32 s98, s51, 1
    s_lshr_b32 s99, s101, 3
    s_and_b32 s96, s48, 3
    s_lshr_b32 s97, s48, 2
    s_lshl_b32 s50, s98, 2
    s_add_u32 s50, s50, s99
    s_lshl_b32 s50, s50, 1
    s_lshl_b32 s51, s99, 1
    s_add_u32 s51, s51, s53
    s_and_b32 s51, s51, 7
    s_mul_i32 s51, s51, 5
    s_lshr_b32 s51, s51, 2
    s_lshl_b32 s58, s51, 7
    s_lshl_b32 s57, s51, 19
    s_mov_b32 s68, 0
    v_lshrrev_b32 v244, 4, v243
    v_lshlrev_b32 v245, 3, v244
    s_lshl_b32 s51, s96, 1
    v_add_u32 v245, s51, v245
    v_and_b32 v246, 15, v243
    v_lshlrev_b32 v247, 4, v246
    v_lshl_add_u32 v240, v245, 13, v247
    v_add_u32 v241, 0x2000, v240
    v_lshl_add_u32 v237, v245, 8, v247
    v_and_b32 v244, 1, v244
    v_xor_b32 v246, v246, v244
    v_lshlrev_b32 v247, 4, v246
    v_lshl_add_u32 v236, v245, 8, v247
    v_bfe_u32 v244, v243, 4, 1
    v_bfe_u32 v245, v243, 3, 1
    v_lshrrev_b32 v246, 5, v243
    v_lshlrev_b32 v247, 2, v244
    v_lshl_add_u32 v247, v245, 3, v247
    v_lshl_add_u32 v247, v246, 4, v247
    s_lshl_b32 s51, s96, 5
    v_add_u32 v247, s51, v247
    v_mul_u32_u24 v247, 0x500, v247
    v_and_b32 v245, 7, v243
    v_xor_b32 v245, v245, v244
    v_lshl_add_u32 v242, v245, 4, v247
    s_mul_i32 s54, s96, 2112
    s_mul_i32 s55, s96, 2176
    s_mov_b32 s44, s55
    s_add_u32 s55, s55, 47104
    s_mul_i32 s56, s96, 4224
    s_add_u32 s56, s56, 81920
    s_waitcnt lgkmcnt(0)
    s_mul_i32 s51, s49, 163840
    s_add_u32 s20, s4, s51
    s_addc_u32 s21, s5, 0
    s_mov_b32 s22, 163840
    s_mov_b32 s23, 0x20000
    s_lshl_b32 s51, s50, 8
    s_add_u32 s32, s10, s51
    s_addc_u32 s33, s11, 0
    s_mov_b32 s34, 0
    s_mov_b32 s35, 0x20000
    s_sub_u32 s34, 5242880, s51
    s_cmp_eq_u32 s97, 0
    s_cbranch_scc1 L_g0a
    s_branch L_s2
L_g0a:
    s_add_u32 m0, s44, 146432
    s_nop 0
    buffer_load_dwordx4 v240, s[32:35], s57 offen lds
    s_add_u32 m0, s44, 147520
    s_nop 0
    buffer_load_dwordx4 v241, s[32:35], s57 offen lds
    s_add_u32 s57, s57, 262144
    s_add_u32 m0, s56, 0
    s_nop 0
    buffer_load_dwordx4 v242, s[20:23], s58 offen lds
    s_add_u32 m0, s56, -224
    s_nop 0
    buffer_load_dwordx4 v242, s[20:23], s58 offen offset:1280 lds
    s_add_u32 m0, s56, -448
    s_nop 0
    buffer_load_dwordx4 v242, s[20:23], s58 offen offset:2560 lds
    s_add_u32 m0, s56, -672
    s_nop 0
    buffer_load_dwordx4 v242, s[20:23], s58 offen offset:3840 lds
    s_add_u32 s58, s58, 128
    s_cmp_eq_u32 s58, 1280
    s_cselect_b32 s58, 0, s58
    s_add_u32 m0, s44, 155136
    s_nop 0
    buffer_load_dwordx4 v240, s[32:35], s57 offen lds
    s_add_u32 m0, s44, 156224
    s_nop 0
    buffer_load_dwordx4 v241, s[32:35], s57 offen lds
    s_add_u32 s57, s57, 262144
    s_and_b32 s69, s57, 256
    s_cmp_ge_u32 s57, 5242880
    s_cselect_b32 s57, s69, s57
L_s2:
    s_lshl_b32 s51, s49, 5
    s_add_u32 s51, s51, s50
    s_add_u32 s51, s51, s68
    s_lshl_b32 s51, s51, 17
    s_add_u32 s24, s6, s51
    s_addc_u32 s25, s7, 0
    s_mov_b32 s26, 131072
    s_mov_b32 s27, 0x20000
    s_add_u32 s28, s8, s51
    s_addc_u32 s29, s9, 0
    s_mov_b32 s30, 131072
    s_mov_b32 s31, 0x20000
    s_mov_b32 s36, s12
    s_mov_b32 s37, s13
    s_mov_b32 s38, 5242880
    s_mov_b32 s39, 0x20000
    s_mov_b32 s40, s18
    s_mov_b32 s41, s19
    s_mov_b32 s42, 50331648
    s_mov_b32 s43, 0x20000
    s_add_u32 s50, s50, s97
    s_and_b32 s51, s2, 7
    s_mul_i32 s51, s51, 2
    s_mul_i32 s52, s101, 3
    s_add_u32 s51, s51, s52
    s_and_b32 s51, s51, 15
    s_lshl_b32 s67, s51, 13
    s_mov_b32 s59, s67
    s_mov_b32 s60, s67
    s_mov_b32 s63, 0x46800000
    s_mov_b32 s64, 0x3e0293ee
    s_lshl_b32 s51, s49, 7
    s_add_u32 s51, s51, 42074112
    buffer_load_dword v232, off, s[40:43], s51 sc1
    s_lshl_b32 s65, s98, 6
    s_add_u32 s65, s65, s96
    s_mul_i32 s65, s65, 20480
    s_mul_i32 s51, s99, 320
    s_add_u32 s65, s65, s51
    s_mul_i32 s66, s96, 5120
    s_mul_i32 s53, s97, 81920
    s_add_u32 s66, s66, s53
    v_lshlrev_b32 v248, 4, v243
    v_add_u32 v244, 0, v243
    v_mul_u32_u24 v245, 3277, v244
    v_lshrrev_b32 v245, 16, v245
    v_mul_u32_u24 v245, 960, v245
    v_lshl_add_u32 v251, v244, 4, v245
    v_add_u32 v244, 64, v243
    v_mul_u32_u24 v245, 3277, v244
    v_lshrrev_b32 v245, 16, v245
    v_mul_u32_u24 v245, 960, v245
    v_lshl_add_u32 v252, v244, 4, v245
    v_add_u32 v244, 128, v243
    v_mul_u32_u24 v245, 3277, v244
    v_lshrrev_b32 v245, 16, v245
    v_mul_u32_u24 v245, 960, v245
    v_lshl_add_u32 v253, v244, 4, v245
    v_add_u32 v244, 192, v243
    v_mul_u32_u24 v245, 3277, v244
    v_lshrrev_b32 v245, 16, v245
    v_mul_u32_u24 v245, 960, v245
    v_lshl_add_u32 v254, v244, 4, v245
    v_add_u32 v244, 256, v243
    v_mul_u32_u24 v245, 3277, v244
    v_lshrrev_b32 v245, 16, v245
    v_mul_u32_u24 v245, 960, v245
    v_lshl_add_u32 v255, v244, 4, v245
    v_and_b32 v244, 7, v243
    v_mul_u32_u24 v244, 1056, v244
    v_bfe_u32 v245, v243, 3, 2
    v_lshl_add_u32 v244, v245, 8, v244
    v_lshrrev_b32 v246, 5, v243
    v_and_b32 v245, 1, v245
    v_xor_b32 v245, v245, v246
    v_lshl_add_u32 v244, v245, 4, v244
    v_add_u32 v234, s53, v244
    v_bfe_u32 v247, v243, 4, 1
    v_bfe_u32 v245, v243, 1, 1
    v_lshl_add_u32 v244, v247, 1, v245
    v_add_u32 v244, s98, v244
    v_and_b32 v244, 3, v244
    v_mul_u32_u24 v249, 80, v244
    v_and_b32 v244, 1, v243
    v_mul_u32_u24 v250, 40, v244
    v_add_u32 v249, v249, v250
    v_lshlrev_b32 v244, 4, v244
    v_lshl_add_u32 v244, v245, 3, v244
    v_bfe_u32 v245, v243, 2, 2
    v_lshl_add_u32 v250, v246, 3, v245
    v_mul_u32_u24 v250, 320, v250
    v_add_u32 v249, v249, v250
    v_add_u32 v250, 40960, v249
    v_lshl_add_u32 v244, v247, 5, v244
    v_mul_u32_u24 v245, 1088, v245
    v_add_u32 v244, v244, v245
    v_lshl_add_u32 v238, v246, 8, v244
    v_add_u32 v238, 115712, v238
    v_mul_u32_u24 v245, 4352, v246
    s_add_u32 s51, s53, 47104
    v_add3_u32 v235, v244, v245, s51
    v_and_b32 v244, 3, v243
    v_mul_u32_u24 v244, 1056, v244
    v_bfe_u32 v245, v243, 3, 1
    v_lshl_add_u32 v244, v245, 7, v244
    v_lshl_add_u32 v244, v247, 9, v244
    v_bfe_u32 v245, v243, 2, 1
    v_lshl_add_u32 v244, v245, 8, v244
    v_xor_b32 v245, v245, v246
    v_lshl_add_u32 v244, v245, 4, v244
    v_add_u32 v239, s56, v244
    s_cmp_lg_u32 s97, 0
    s_cbranch_scc1 L_g1
    v_mov_b32 v0, 0
    v_mov_b32 v1, 0
    v_mov_b32 v2, 0
    v_mov_b32 v3, 0
    v_mov_b32 v4, 0
    v_mov_b32 v5, 0
    v_mov_b32 v6, 0
    v_mov_b32 v7, 0
    v_mov_b32 v8, 0
    v_mov_b32 v9, 0
    v_mov_b32 v10, 0
    v_mov_b32 v11, 0
    v_mov_b32 v12, 0
    v_mov_b32 v13, 0
    v_mov_b32 v14, 0
    v_mov_b32 v15, 0
    v_mov_b32 v16, 0
    v_mov_b32 v17, 0
    v_mov_b32 v18, 0
    v_mov_b32 v19, 0
    v_mov_b32 v20, 0
    v_mov_b32 v21, 0
    v_mov_b32 v22, 0
    v_mov_b32 v23, 0
    v_mov_b32 v24, 0
    v_mov_b32 v25, 0
    v_mov_b32 v26, 0
    v_mov_b32 v27, 0
    v_mov_b32 v28, 0
    v_mov_b32 v29, 0
    v_mov_b32 v30, 0
    v_mov_b32 v31, 0
    v_mov_b32 v32, 0
    v_mov_b32 v33, 0
    v_mov_b32 v34, 0
    v_mov_b32 v35, 0
    v_mov_b32 v36, 0
    v_mov_b32 v37, 0
    v_mov_b32 v38, 0
    v_mov_b32 v39, 0
    v_mov_b32 v40, 0
    v_mov_b32 v41, 0
    v_mov_b32 v42, 0
    v_mov_b32 v43, 0
    v_mov_b32 v44, 0
    v_mov_b32 v45, 0
    v_mov_b32 v46, 0
    v_mov_b32 v47, 0
    v_mov_b32 v48, 0
    v_mov_b32 v49, 0
    v_mov_b32 v50, 0
    v_mov_b32 v51, 0
    v_mov_b32 v52, 0
    v_mov_b32 v53, 0
    v_mov_b32 v54, 0
    v_mov_b32 v55, 0
    v_mov_b32 v56, 0
    v_mov_b32 v57, 0
    v_mov_b32 v58, 0
    v_mov_b32 v59, 0
    v_mov_b32 v60, 0
    v_mov_b32 v61, 0
    v_mov_b32 v62, 0
    v_mov_b32 v63, 0
    s_add_u32 s59, s67, 32768
    s_add_u32 s60, s67, 16384
    s_and_b32 s59, s59, 0x1ffff
    s_and_b32 s60, s60, 0x1ffff
    s_waitcnt vmcnt(3)
    s_barrier
    ds_read_b128 v[112:115], v239 offset:0
    ds_read_b128 v[116:119], v239 offset:32
    ds_read_b128 v[120:123], v239 offset:64
    ds_read_b128 v[124:127], v239 offset:96
    ds_read_b64_tr_b16 v[160:161], v238 offset:30720
    ds_read_b64_tr_b16 v[162:163], v238 offset:35072
    ds_read_b64_tr_b16 v[164:165], v238 offset:30784
    ds_read_b64_tr_b16 v[166:167], v238 offset:35136
    ds_read_b64_tr_b16 v[168:169], v238 offset:30848
    ds_read_b64_tr_b16 v[170:171], v238 offset:35200
    ds_read_b64_tr_b16 v[172:173], v238 offset:30912
    ds_read_b64_tr_b16 v[174:175], v238 offset:35264
    ds_read_b64_tr_b16 v[176:177], v238 offset:31232
    ds_read_b64_tr_b16 v[178:179], v238 offset:35584
    ds_read_b64_tr_b16 v[180:181], v238 offset:31296
    ds_read_b64_tr_b16 v[182:183], v238 offset:35648
    ds_read_b64_tr_b16 v[184:185], v238 offset:31360
    ds_read_b64_tr_b16 v[186:187], v238 offset:35712
    ds_read_b64_tr_b16 v[188:189], v238 offset:31424
    ds_read_b64_tr_b16 v[190:191], v238 offset:35776
    s_waitcnt vmcnt(1)
    s_mov_b32 s61, 4
L_f_qp_loop0:
    s_waitcnt lgkmcnt(0)
    s_barrier
    v_mfma_f32_32x32x16_bf16 v[0:15], v[160:163], v[112:115], v[0:15]
    ds_read_b64_tr_b16 v[192:193], v238 offset:39424
    ds_read_b64_tr_b16 v[194:195], v238 offset:43776
    ds_read_b64_tr_b16 v[196:197], v238 offset:39488
    v_mfma_f32_32x32x16_bf16 v[16:31], v[164:167], v[112:115], v[16:31]
    ds_read_b64_tr_b16 v[198:199], v238 offset:43840
    ds_read_b64_tr_b16 v[200:201], v238 offset:39552
    ds_read_b64_tr_b16 v[202:203], v238 offset:43904
    v_mfma_f32_32x32x16_bf16 v[32:47], v[168:171], v[112:115], v[32:47]
    ds_read_b64_tr_b16 v[204:205], v238 offset:39616
    ds_read_b64_tr_b16 v[206:207], v238 offset:43968
    ds_read_b64_tr_b16 v[208:209], v238 offset:39936
    v_mfma_f32_32x32x16_bf16 v[48:63], v[172:175], v[112:115], v[48:63]
    ds_read_b64_tr_b16 v[210:211], v238 offset:44288
    ds_read_b64_tr_b16 v[212:213], v238 offset:40000
    ds_read_b64_tr_b16 v[214:215], v238 offset:44352
    v_mfma_f32_32x32x16_bf16 v[0:15], v[176:179], v[116:119], v[0:15]
    ds_read_b64_tr_b16 v[216:217], v238 offset:40064
    ds_read_b64_tr_b16 v[218:219], v238 offset:44416
    ds_read_b64_tr_b16 v[220:221], v238 offset:40128
    v_mfma_f32_32x32x16_bf16 v[16:31], v[180:183], v[116:119], v[16:31]
    ds_read_b64_tr_b16 v[222:223], v238 offset:44480
    v_mfma_f32_32x32x16_bf16 v[32:47], v[184:187], v[116:119], v[32:47]
    v_mfma_f32_32x32x16_bf16 v[48:63], v[188:191], v[116:119], v[48:63]
    s_waitcnt lgkmcnt(0)
    s_barrier
    v_mfma_f32_32x32x16_bf16 v[0:15], v[192:195], v[120:123], v[0:15]
    ds_read_b128 v[128:131], v239 offset:16896
    ds_read_b128 v[132:135], v239 offset:16928
    ds_read_b128 v[136:139], v239 offset:16960
    ds_read_b128 v[140:143], v239 offset:16992
    v_mfma_f32_32x32x16_bf16 v[16:31], v[196:199], v[120:123], v[16:31]
    ds_read_b64_tr_b16 v[160:161], v238 offset:13312
    ds_read_b64_tr_b16 v[162:163], v238 offset:17664
    ds_read_b64_tr_b16 v[164:165], v238 offset:13376
    ds_read_b64_tr_b16 v[166:167], v238 offset:17728
    v_mfma_f32_32x32x16_bf16 v[32:47], v[200:203], v[120:123], v[32:47]
    ds_read_b64_tr_b16 v[168:169], v238 offset:13440
    ds_read_b64_tr_b16 v[170:171], v238 offset:17792
    ds_read_b64_tr_b16 v[172:173], v238 offset:13504
    ds_read_b64_tr_b16 v[174:175], v238 offset:17856
    v_mfma_f32_32x32x16_bf16 v[48:63], v[204:207], v[120:123], v[48:63]
    ds_read_b64_tr_b16 v[176:177], v238 offset:13824
    ds_read_b64_tr_b16 v[178:179], v238 offset:18176
    ds_read_b64_tr_b16 v[180:181], v238 offset:13888
    ds_read_b64_tr_b16 v[182:183], v238 offset:18240
    v_mfma_f32_32x32x16_bf16 v[0:15], v[208:211], v[124:127], v[0:15]
    ds_read_b64_tr_b16 v[184:185], v238 offset:13952
    ds_read_b64_tr_b16 v[186:187], v238 offset:18304
    ds_read_b64_tr_b16 v[188:189], v238 offset:14016
    ds_read_b64_tr_b16 v[190:191], v238 offset:18368
    v_mfma_f32_32x32x16_bf16 v[16:31], v[212:215], v[124:127], v[16:31]
    v_mfma_f32_32x32x16_bf16 v[32:47], v[216:219], v[124:127], v[32:47]
    v_mfma_f32_32x32x16_bf16 v[48:63], v[220:223], v[124:127], v[48:63]
    s_waitcnt lgkmcnt(0)
    s_barrier
    v_mfma_f32_32x32x16_bf16 v[0:15], v[160:163], v[128:131], v[0:15]
    ds_read_b64_tr_b16 v[192:193], v238 offset:22016
    ds_read_b64_tr_b16 v[194:195], v238 offset:26368
    ds_read_b64_tr_b16 v[196:197], v238 offset:22080
    v_mfma_f32_32x32x16_bf16 v[16:31], v[164:167], v[128:131], v[16:31]
    ds_read_b64_tr_b16 v[198:199], v238 offset:26432
    ds_read_b64_tr_b16 v[200:201], v238 offset:22144
    ds_read_b64_tr_b16 v[202:203], v238 offset:26496
    v_mfma_f32_32x32x16_bf16 v[32:47], v[168:171], v[128:131], v[32:47]
    ds_read_b64_tr_b16 v[204:205], v238 offset:22208
    ds_read_b64_tr_b16 v[206:207], v238 offset:26560
    ds_read_b64_tr_b16 v[208:209], v238 offset:22528
    v_mfma_f32_32x32x16_bf16 v[48:63], v[172:175], v[128:131], v[48:63]
    ds_read_b64_tr_b16 v[210:211], v238 offset:26880
    ds_read_b64_tr_b16 v[212:213], v238 offset:22592
    ds_read_b64_tr_b16 v[214:215], v238 offset:26944
    v_mfma_f32_32x32x16_bf16 v[0:15], v[176:179], v[132:135], v[0:15]
    ds_read_b64_tr_b16 v[216:217], v238 offset:22656
    ds_read_b64_tr_b16 v[218:219], v238 offset:27008
    ds_read_b64_tr_b16 v[220:221], v238 offset:22720
    v_mfma_f32_32x32x16_bf16 v[16:31], v[180:183], v[132:135], v[16:31]
    ds_read_b64_tr_b16 v[222:223], v238 offset:27072
    v_mfma_f32_32x32x16_bf16 v[32:47], v[184:187], v[132:135], v[32:47]
    v_mfma_f32_32x32x16_bf16 v[48:63], v[188:191], v[132:135], v[48:63]
    s_waitcnt lgkmcnt(0)
    s_barrier
    v_mfma_f32_32x32x16_bf16 v[0:15], v[192:195], v[136:139], v[0:15]
    ds_read_b128 v[112:115], v239 offset:0
    ds_read_b128 v[116:119], v239 offset:32
    ds_read_b128 v[120:123], v239 offset:64
    ds_read_b128 v[124:127], v239 offset:96
    v_mfma_f32_32x32x16_bf16 v[16:31], v[196:199], v[136:139], v[16:31]
    ds_read_b64_tr_b16 v[160:161], v238 offset:30720
    ds_read_b64_tr_b16 v[162:163], v238 offset:35072
    ds_read_b64_tr_b16 v[164:165], v238 offset:30784
    ds_read_b64_tr_b16 v[166:167], v238 offset:35136
    v_mfma_f32_32x32x16_bf16 v[32:47], v[200:203], v[136:139], v[32:47]
    ds_read_b64_tr_b16 v[168:169], v238 offset:30848
    ds_read_b64_tr_b16 v[170:171], v238 offset:35200
    ds_read_b64_tr_b16 v[172:173], v238 offset:30912
    ds_read_b64_tr_b16 v[174:175], v238 offset:35264
    v_mfma_f32_32x32x16_bf16 v[48:63], v[204:207], v[136:139], v[48:63]
    ds_read_b64_tr_b16 v[176:177], v238 offset:31232
    ds_read_b64_tr_b16 v[178:179], v238 offset:35584
    ds_read_b64_tr_b16 v[180:181], v238 offset:31296
    ds_read_b64_tr_b16 v[182:183], v238 offset:35648
    v_mfma_f32_32x32x16_bf16 v[0:15], v[208:211], v[140:143], v[0:15]
    ds_read_b64_tr_b16 v[184:185], v238 offset:31360
    ds_read_b64_tr_b16 v[186:187], v238 offset:35712
    ds_read_b64_tr_b16 v[188:189], v238 offset:31424
    ds_read_b64_tr_b16 v[190:191], v238 offset:35776
    v_mfma_f32_32x32x16_bf16 v[16:31], v[212:215], v[140:143], v[16:31]
    v_mfma_f32_32x32x16_bf16 v[32:47], v[216:219], v[140:143], v[32:47]
    v_mfma_f32_32x32x16_bf16 v[48:63], v[220:223], v[140:143], v[48:63]
    s_sub_u32 s61, s61, 1
    s_cmp_lg_u32 s61, 0
    s_cbranch_scc1 L_f_qp_loop0
    s_waitcnt lgkmcnt(0)
    s_barrier
    v_mfma_f32_32x32x16_bf16 v[0:15], v[160:163], v[112:115], v[0:15]
    ds_read_b64_tr_b16 v[192:193], v238 offset:39424
    ds_read_b64_tr_b16 v[194:195], v238 offset:43776
    ds_read_b64_tr_b16 v[196:197], v238 offset:39488
    v_mfma_f32_32x32x16_bf16 v[16:31], v[164:167], v[112:115], v[16:31]
    ds_read_b64_tr_b16 v[198:199], v238 offset:43840
    ds_read_b64_tr_b16 v[200:201], v238 offset:39552
    ds_read_b64_tr_b16 v[202:203], v238 offset:43904
    v_mfma_f32_32x32x16_bf16 v[32:47], v[168:171], v[112:115], v[32:47]
    ds_read_b64_tr_b16 v[204:205], v238 offset:39616
    ds_read_b64_tr_b16 v[206:207], v238 offset:43968
    ds_read_b64_tr_b16 v[208:209], v238 offset:39936
    v_mfma_f32_32x32x16_bf16 v[48:63], v[172:175], v[112:115], v[48:63]
    ds_read_b64_tr_b16 v[210:211], v238 offset:44288
    ds_read_b64_tr_b16 v[212:213], v238 offset:40000
    ds_read_b64_tr_b16 v[214:215], v238 offset:44352
    v_mfma_f32_32x32x16_bf16 v[0:15], v[176:179], v[116:119], v[0:15]
    ds_read_b64_tr_b16 v[216:217], v238 offset:40064
    ds_read_b64_tr_b16 v[218:219], v238 offset:44416
    ds_read_b64_tr_b16 v[220:221], v238 offset:40128
    v_mfma_f32_32x32x16_bf16 v[16:31], v[180:183], v[116:119], v[16:31]
    ds_read_b64_tr_b16 v[222:223], v238 offset:44480
    v_mfma_f32_32x32x16_bf16 v[32:47], v[184:187], v[116:119], v[32:47]
    v_mfma_f32_32x32x16_bf16 v[48:63], v[188:191], v[116:119], v[48:63]
    s_waitcnt lgkmcnt(0)
    s_barrier
    v_mfma_f32_32x32x16_bf16 v[0:15], v[192:195], v[120:123], v[0:15]
    ds_read_b128 v[128:131], v239 offset:16896
    ds_read_b128 v[132:135], v239 offset:16928
    ds_read_b128 v[136:139], v239 offset:16960
    ds_read_b128 v[140:143], v239 offset:16992
    v_mfma_f32_32x32x16_bf16 v[16:31], v[196:199], v[120:123], v[16:31]
    ds_read_b64_tr_b16 v[160:161], v238 offset:13312
    ds_read_b64_tr_b16 v[162:163], v238 offset:17664
    ds_read_b64_tr_b16 v[164:165], v238 offset:13376
    ds_read_b64_tr_b16 v[166:167], v238 offset:17728
    v_mfma_f32_32x32x16_bf16 v[32:47], v[200:203], v[120:123], v[32:47]
    ds_read_b64_tr_b16 v[168:169], v238 offset:13440
    ds_read_b64_tr_b16 v[170:171], v238 offset:17792
    ds_read_b64_tr_b16 v[172:173], v238 offset:13504
    ds_read_b64_tr_b16 v[174:175], v238 offset:17856
    v_mfma_f32_32x32x16_bf16 v[48:63], v[204:207], v[120:123], v[48:63]
    ds_read_b64_tr_b16 v[176:177], v238 offset:13824
    ds_read_b64_tr_b16 v[178:179], v238 offset:18176
    ds_read_b64_tr_b16 v[180:181], v238 offset:13888
    ds_read_b64_tr_b16 v[182:183], v238 offset:18240
    v_mfma_f32_32x32x16_bf16 v[0:15], v[208:211], v[124:127], v[0:15]
    ds_read_b64_tr_b16 v[184:185], v238 offset:13952
    ds_read_b64_tr_b16 v[186:187], v238 offset:18304
    ds_read_b64_tr_b16 v[188:189], v238 offset:14016
    ds_read_b64_tr_b16 v[190:191], v238 offset:18368
    v_mfma_f32_32x32x16_bf16 v[16:31], v[212:215], v[124:127], v[16:31]
    v_mfma_f32_32x32x16_bf16 v[32:47], v[216:219], v[124:127], v[32:47]
    v_mfma_f32_32x32x16_bf16 v[48:63], v[220:223], v[124:127], v[48:63]
    s_waitcnt lgkmcnt(0)
    s_barrier
    v_mfma_f32_32x32x16_bf16 v[0:15], v[160:163], v[128:131], v[0:15]
    ds_read_b64_tr_b16 v[192:193], v238 offset:22016
    ds_read_b64_tr_b16 v[194:195], v238 offset:26368
    ds_read_b64_tr_b16 v[196:197], v238 offset:22080
    v_mfma_f32_32x32x16_bf16 v[16:31], v[164:167], v[128:131], v[16:31]
    ds_read_b64_tr_b16 v[198:199], v238 offset:26432
    ds_read_b64_tr_b16 v[200:201], v238 offset:22144
    ds_read_b64_tr_b16 v[202:203], v238 offset:26496
    v_mfma_f32_32x32x16_bf16 v[32:47], v[168:171], v[128:131], v[32:47]
    ds_read_b64_tr_b16 v[204:205], v238 offset:22208
    ds_read_b64_tr_b16 v[206:207], v238 offset:26560
    ds_read_b64_tr_b16 v[208:209], v238 offset:22528
    v_mfma_f32_32x32x16_bf16 v[48:63], v[172:175], v[128:131], v[48:63]
    ds_read_b64_tr_b16 v[210:211], v238 offset:26880
    ds_read_b64_tr_b16 v[212:213], v238 offset:22592
    ds_read_b64_tr_b16 v[214:215], v238 offset:26944
    v_mfma_f32_32x32x16_bf16 v[0:15], v[176:179], v[132:135], v[0:15]
    ds_read_b64_tr_b16 v[216:217], v238 offset:22656
    ds_read_b64_tr_b16 v[218:219], v238 offset:27008
    ds_read_b64_tr_b16 v[220:221], v238 offset:22720
    v_mfma_f32_32x32x16_bf16 v[16:31], v[180:183], v[132:135], v[16:31]
    ds_read_b64_tr_b16 v[222:223], v238 offset:27072
    v_mfma_f32_32x32x16_bf16 v[32:47], v[184:187], v[132:135], v[32:47]
    v_mfma_f32_32x32x16_bf16 v[48:63], v[188:191], v[132:135], v[48:63]
    s_waitcnt lgkmcnt(0)
    s_barrier
    v_mfma_f32_32x32x16_bf16 v[0:15], v[192:195], v[136:139], v[0:15]
    ds_read_b128 v[160:163], v234 offset:0
    ds_read_b128 v[164:167], v234 offset:32
    ds_read_b128 v[168:171], v234 offset:64
    v_mfma_f32_32x32x16_bf16 v[16:31], v[196:199], v[136:139], v[16:31]
    ds_read_b128 v[172:175], v234 offset:96
    ds_read_b128 v[176:179], v234 offset:128
    ds_read_b128 v[180:183], v234 offset:160
    v_mfma_f32_32x32x16_bf16 v[32:47], v[200:203], v[136:139], v[32:47]
    ds_read_b128 v[184:187], v234 offset:192
    ds_read_b128 v[188:191], v234 offset:224
    ds_read_b128 v[96:99], v234 offset:8448
    v_mfma_f32_32x32x16_bf16 v[48:63], v[204:207], v[136:139], v[48:63]
    ds_read_b128 v[100:103], v234 offset:8480
    ds_read_b128 v[104:107], v234 offset:8512
    ds_read_b128 v[108:111], v234 offset:8544
    v_mfma_f32_32x32x16_bf16 v[0:15], v[208:211], v[140:143], v[0:15]
    ds_read_b128 v[144:147], v234 offset:8576
    ds_read_b128 v[148:151], v234 offset:8608
    ds_read_b128 v[152:155], v234 offset:8640
    v_mfma_f32_32x32x16_bf16 v[16:31], v[212:215], v[140:143], v[16:31]
    ds_read_b128 v[156:159], v234 offset:8672
    v_mfma_f32_32x32x16_bf16 v[32:47], v[216:219], v[140:143], v[32:47]
    v_mfma_f32_32x32x16_bf16 v[48:63], v[220:223], v[140:143], v[48:63]
    s_waitcnt vmcnt(0)
    v_readfirstlane_b32 s100, v232
    s_nop 0
    s_mul_i32 s100, s100, 0x9e3779b1
    s_add_u32 s100, s100, 0x7f4a7c15
    s_branch L_shared
L_g1:
    v_mov_b32 v0, 0
    v_mov_b32 v1, 0
    v_mov_b32 v2, 0
    v_mov_b32 v3, 0
    v_mov_b32 v4, 0
    v_mov_b32 v5, 0
    v_mov_b32 v6, 0
    v_mov_b32 v7, 0
    v_mov_b32 v8, 0
    v_mov_b32 v9, 0
    v_mov_b32 v10, 0
    v_mov_b32 v11, 0
    v_mov_b32 v12, 0
    v_mov_b32 v13, 0
    v_mov_b32 v14, 0
    v_mov_b32 v15, 0
    v_mov_b32 v16, 0
    v_mov_b32 v17, 0
    v_mov_b32 v18, 0
    v_mov_b32 v19, 0
    v_mov_b32 v20, 0
    v_mov_b32 v21, 0
    v_mov_b32 v22, 0
    v_mov_b32 v23, 0
    v_mov_b32 v24, 0
    v_mov_b32 v25, 0
    v_mov_b32 v26, 0
    v_mov_b32 v27, 0
    v_mov_b32 v28, 0
    v_mov_b32 v29, 0
    v_mov_b32 v30, 0
    v_mov_b32 v31, 0
    v_mov_b32 v32, 0
    v_mov_b32 v33, 0
    v_mov_b32 v34, 0
    v_mov_b32 v35, 0
    v_mov_b32 v36, 0
    v_mov_b32 v37, 0
    v_mov_b32 v38, 0
    v_mov_b32 v39, 0
    v_mov_b32 v40, 0
    v_mov_b32 v41, 0
    v_mov_b32 v42, 0
    v_mov_b32 v43, 0
    v_mov_b32 v44, 0
    v_mov_b32 v45, 0
    v_mov_b32 v46, 0
    v_mov_b32 v47, 0
    v_mov_b32 v48, 0
    v_mov_b32 v49, 0
    v_mov_b32 v50, 0
    v_mov_b32 v51, 0
    v_mov_b32 v52, 0
    v_mov_b32 v53, 0
    v_mov_b32 v54, 0
    v_mov_b32 v55, 0
    v_mov_b32 v56, 0
    v_mov_b32 v57, 0
    v_mov_b32 v58, 0
    v_mov_b32 v59, 0
    v_mov_b32 v60, 0
    v_mov_b32 v61, 0
    v_mov_b32 v62, 0
    v_mov_b32 v63, 0
    s_add_u32 s57, s57, 262144
    s_add_u32 s58, s58, 128
    s_cmp_eq_u32 s58, 1280
    s_cselect_b32 s58, 0, s58
    s_add_u32 s57, s57, 262144
    s_and_b32 s69, s57, 256
    s_cmp_ge_u32 s57, 5242880
    s_cselect_b32 s57, s69, s57
    s_add_u32 m0, s56, 16896
    s_nop 0
    buffer_load_dwordx4 v242, s[20:23], s58 offen lds
    s_add_u32 m0, s56, 16672
    s_nop 0
    buffer_load_dwordx4 v242, s[20:23], s58 offen offset:1280 lds
    s_add_u32 m0, s56, 16448
    s_nop 0
    buffer_load_dwordx4 v242, s[20:23], s58 offen offset:2560 lds
    s_add_u32 m0, s56, 16224
    s_nop 0
    buffer_load_dwordx4 v242, s[20:23], s58 offen offset:3840 lds
    s_add_u32 s58, s58, 128
    s_cmp_eq_u32 s58, 1280
    s_cselect_b32 s58, 0, s58
    s_add_u32 m0, s44, 129024
    s_nop 0
    buffer_load_dwordx4 v240, s[32:35], s57 offen lds
    s_add_u32 m0, s44, 130112
    s_nop 0
    buffer_load_dwordx4 v241, s[32:35], s57 offen lds
    s_add_u32 s57, s57, 262144
    s_add_u32 m0, s44, 137728
    s_nop 0
    buffer_load_dwordx4 v240, s[32:35], s57 offen lds
    s_add_u32 m0, s44, 138816
    s_nop 0
    buffer_load_dwordx4 v241, s[32:35], s57 offen lds
    s_add_u32 s57, s57, 262144
    s_and_b32 s69, s57, 256
    s_cmp_ge_u32 s57, 5242880
    s_cselect_b32 s57, s69, s57
    s_barrier
    ds_read_b128 v[64:67], v239 offset:0
    ds_read_b128 v[68:71], v239 offset:32
    ds_read_b128 v[72:75], v239 offset:64
    ds_read_b128 v[76:79], v239 offset:96
    s_waitcnt lgkmcnt(0)
    s_barrier
    s_add_u32 m0, s56, 0
    s_nop 0
    buffer_load_dwordx4 v242, s[20:23], s58 offen lds
    s_add_u32 m0, s56, -224
    s_nop 0
    buffer_load_dwordx4 v242, s[20:23], s58 offen offset:1280 lds
    s_add_u32 m0, s56, -448
    s_nop 0
    buffer_load_dwordx4 v242, s[20:23], s58 offen offset:2560 lds
    s_add_u32 m0, s56, -672
    s_nop 0
    buffer_load_dwordx4 v242, s[20:23], s58 offen offset:3840 lds
    s_add_u32 s58, s58, 128
    s_cmp_eq_u32 s58, 1280
    s_cselect_b32 s58, 0, s58
    s_add_u32 m0, s44, 146432
    s_nop 0
    buffer_load_dwordx4 v240, s[32:35], s57 offen lds
    s_add_u32 m0, s44, 147520
    s_nop 0
    buffer_load_dwordx4 v241, s[32:35], s57 offen lds
    s_add_u32 s57, s57, 262144
    s_waitcnt vmcnt(8)
    s_barrier
    s_add_u32 m0, s44, 155136
    s_nop 0
    buffer_load_dwordx4 v240, s[32:35], s57 offen lds
    s_add_u32 m0, s44, 156224
    s_nop 0
    buffer_load_dwordx4 v241, s[32:35], s57 offen lds
    s_add_u32 s57, s57, 262144
    s_and_b32 s69, s57, 256
    s_cmp_ge_u32 s57, 5242880
    s_cselect_b32 s57, s69, s57
    ds_read_b128 v[80:83], v239 offset:16896
    ds_read_b128 v[84:87], v239 offset:16928
    ds_read_b128 v[88:91], v239 offset:16960
    ds_read_b128 v[92:95], v239 offset:16992
    s_waitcnt vmcnt(8) lgkmcnt(0)
    s_barrier
    s_add_u32 m0, s56, 16896
    s_nop 0
    buffer_load_dwordx4 v242, s[20:23], s58 offen lds
    s_add_u32 m0, s56, 16672
    s_nop 0
    buffer_load_dwordx4 v242, s[20:23], s58 offen offset:1280 lds
    s_add_u32 m0, s56, 16448
    s_nop 0
    buffer_load_dwordx4 v242, s[20:23], s58 offen offset:2560 lds
    s_add_u32 m0, s56, 16224
    s_nop 0
    buffer_load_dwordx4 v242, s[20:23], s58 offen offset:3840 lds
    s_add_u32 s58, s58, 128
    s_cmp_eq_u32 s58, 1280
    s_cselect_b32 s58, 0, s58
    s_add_u32 m0, s44, 129024
    s_nop 0
    buffer_load_dwordx4 v240, s[32:35], s57 offen lds
    s_add_u32 m0, s44, 130112
    s_nop 0
    buffer_load_dwordx4 v241, s[32:35], s57 offen lds
    s_add_u32 s57, s57, 262144
    s_waitcnt vmcnt(8)
    s_barrier
    s_add_u32 m0, s44, 137728
    s_nop 0
    buffer_load_dwordx4 v240, s[32:35], s57 offen lds
    s_add_u32 m0, s44, 138816
    s_nop 0
    buffer_load_dwordx4 v241, s[32:35], s57 offen lds
    s_add_u32 s57, s57, 262144
    s_and_b32 s69, s57, 256
    s_cmp_ge_u32 s57, 5242880
    s_cselect_b32 s57, s69, s57
    ds_read_b128 v[96:99], v239 offset:0
    ds_read_b128 v[100:103], v239 offset:32
    ds_read_b128 v[104:107], v239 offset:64
    ds_read_b128 v[108:111], v239 offset:96
    s_waitcnt vmcnt(8) lgkmcnt(0)
    s_barrier
    s_add_u32 m0, s56, 0
    s_nop 0
    buffer_load_dwordx4 v242, s[20:23], s58 offen lds
    s_add_u32 m0, s56, -224
    s_nop 0
    buffer_load_dwordx4 v242, s[20:23], s58 offen offset:1280 lds
    s_add_u32 m0, s56, -448
    s_nop 0
    buffer_load_dwordx4 v242, s[20:23], s58 offen offset:2560 lds
    s_add_u32 m0, s56, -672
    s_nop 0
    buffer_load_dwordx4 v242, s[20:23], s58 offen offset:3840 lds
    s_add_u32 s58, s58, 128
    s_cmp_eq_u32 s58, 1280
    s_cselect_b32 s58, 0, s58
    s_add_u32 m0, s44, 146432
    s_nop 0
    buffer_load_dwordx4 v240, s[32:35], s57 offen lds
    s_add_u32 m0, s44, 147520
    s_nop 0
    buffer_load_dwordx4 v241, s[32:35], s57 offen lds
    s_add_u32 s57, s57, 262144
    s_add_u32 m0, s54, 0
    s_nop 0
    buffer_load_dwordx4 v236, s[24:27], s59 offen nt lds
    s_add_u32 m0, s54, 800
    s_nop 0
    buffer_load_dwordx4 v236, s[24:27], s59 offen offset:256 nt lds
    s_add_u32 s59, s59, 8192
    s_and_b32 s59, s59, 0x1ffff
    v_readfirstlane_b32 s100, v232
    s_nop 0
    s_mul_i32 s100, s100, 0x9e3779b1
    s_add_u32 s100, s100, 0x7f4a7c15
    s_waitcnt vmcnt(10)
    s_barrier
    s_add_u32 m0, s44, 155136
    s_nop 0
    buffer_load_dwordx4 v240, s[32:35], s57 offen lds
    s_add_u32 m0, s44, 156224
    s_nop 0
    buffer_load_dwordx4 v241, s[32:35], s57 offen lds
    s_add_u32 s57, s57, 262144
    s_and_b32 s69, s57, 256
    s_cmp_ge_u32 s57, 5242880
    s_cselect_b32 s57, s69, s57
    s_add_u32 m0, s54, 8448
    s_nop 0
    buffer_load_dwordx4 v236, s[24:27], s59 offen nt lds
    s_add_u32 m0, s54, 9248
    s_nop 0
    buffer_load_dwordx4 v236, s[24:27], s59 offen offset:256 nt lds
    s_add_u32 s59, s59, 8192
    s_and_b32 s59, s59, 0x1ffff
    ds_read_b128 v[144:147], v239 offset:16896
    ds_read_b128 v[148:151], v239 offset:16928
    ds_read_b128 v[152:155], v239 offset:16960
    ds_read_b128 v[156:159], v239 offset:16992
    s_waitcnt vmcnt(12) lgkmcnt(0)
    s_barrier
    s_add_u32 m0, s56, 16896
    s_nop 0
    buffer_load_dwordx4 v242, s[20:23], s58 offen lds
    s_add_u32 m0, s56, 16672
    s_nop 0
    buffer_load_dwordx4 v242, s[20:23], s58 offen offset:1280 lds
    s_add_u32 m0, s56, 16448
    s_nop 0
    buffer_load_dwordx4 v242, s[20:23], s58 offen offset:2560 lds
    s_add_u32 m0, s56, 16224
    s_nop 0
    buffer_load_dwordx4 v242, s[20:23], s58 offen offset:3840 lds
    s_add_u32 s58, s58, 128
    s_cmp_eq_u32 s58, 1280
    s_cselect_b32 s58, 0, s58
    s_add_u32 m0, s44, 129024
    s_nop 0
    buffer_load_dwordx4 v240, s[32:35], s57 offen lds
    s_add_u32 m0, s44, 130112
    s_nop 0
    buffer_load_dwordx4 v241, s[32:35], s57 offen lds
    s_add_u32 s57, s57, 262144
    s_add_u32 m0, s54, 16896
    s_nop 0
    buffer_load_dwordx4 v236, s[24:27], s59 offen nt lds
    s_add_u32 m0, s54, 17696
    s_nop 0
    buffer_load_dwordx4 v236, s[24:27], s59 offen offset:256 nt lds
    s_add_u32 s59, s59, 8192
    s_and_b32 s59, s59, 0x1ffff
    s_waitcnt vmcnt(14)
    s_barrier
    s_add_u32 m0, s44, 137728
    s_nop 0
    buffer_load_dwordx4 v240, s[32:35], s57 offen lds
    s_add_u32 m0, s44, 138816
    s_nop 0
    buffer_load_dwordx4 v241, s[32:35], s57 offen lds
    s_add_u32 s57, s57, 262144
    s_and_b32 s69, s57, 256
    s_cmp_ge_u32 s57, 5242880
    s_cselect_b32 s57, s69, s57
    s_add_u32 m0, s55, 0
    s_nop 0
    buffer_load_dwordx4 v237, s[28:31], s60 offen nt lds
    s_add_u32 m0, s55, 832
    s_nop 0
    buffer_load_dwordx4 v237, s[28:31], s60 offen offset:256 nt lds
    s_add_u32 s60, s60, 8192
    s_and_b32 s60, s60, 0x1ffff
    ds_read_b128 v[160:163], v239 offset:0
    ds_read_b128 v[164:167], v239 offset:32
    ds_read_b128 v[168:171], v239 offset:64
    ds_read_b128 v[172:175], v239 offset:96
    s_waitcnt vmcnt(14) lgkmcnt(0)
    s_barrier
    s_add_u32 m0, s56, 0
    s_nop 0
    buffer_load_dwordx4 v242, s[20:23], s58 offen lds
    s_add_u32 m0, s56, -224
    s_nop 0
    buffer_load_dwordx4 v242, s[20:23], s58 offen offset:1280 lds
    s_add_u32 m0, s56, -448
    s_nop 0
    buffer_load_dwordx4 v242, s[20:23], s58 offen offset:2560 lds
    s_add_u32 m0, s56, -672
    s_nop 0
    buffer_load_dwordx4 v242, s[20:23], s58 offen offset:3840 lds
    s_add_u32 s58, s58, 128
    s_cmp_eq_u32 s58, 1280
    s_cselect_b32 s58, 0, s58
    s_add_u32 m0, s44, 146432
    s_nop 0
    buffer_load_dwordx4 v240, s[32:35], s57 offen lds
    s_add_u32 m0, s44, 147520
    s_nop 0
    buffer_load_dwordx4 v241, s[32:35], s57 offen lds
    s_add_u32 s57, s57, 262144
    s_add_u32 m0, s54, 25344
    s_nop 0
    buffer_load_dwordx4 v236, s[24:27], s59 offen nt lds
    s_add_u32 m0, s54, 26144
    s_nop 0
    buffer_load_dwordx4 v236, s[24:27], s59 offen offset:256 nt lds
    s_add_u32 s59, s59, 8192
    s_and_b32 s59, s59, 0x1ffff
    s_waitcnt vmcnt(14)
    s_barrier
    s_add_u32 m0, s44, 155136
    s_nop 0
    buffer_load_dwordx4 v240, s[32:35], s57 offen lds
    s_add_u32 m0, s44, 156224
    s_nop 0
    buffer_load_dwordx4 v241, s[32:35], s57 offen lds
    s_add_u32 s57, s57, 262144
    s_and_b32 s69, s57, 256
    s_cmp_ge_u32 s57, 5242880
    s_cselect_b32 s57, s69, s57
    s_add_u32 m0, s55, 8704
    s_nop 0
    buffer_load_dwordx4 v237, s[28:31], s60 offen nt lds
    s_add_u32 m0, s55, 9536
    s_nop 0
    buffer_load_dwordx4 v237, s[28:31], s60 offen offset:256 nt lds
    s_add_u32 s60, s60, 8192
    s_and_b32 s60, s60, 0x1ffff
    ds_read_b128 v[176:179], v239 offset:16896
    ds_read_b128 v[180:183], v239 offset:16928
    ds_read_b128 v[184:187], v239 offset:16960
    ds_read_b128 v[188:191], v239 offset:16992
    s_waitcnt vmcnt(14) lgkmcnt(0)
    s_barrier
    s_add_u32 m0, s56, 16896
    s_nop 0
    buffer_load_dwordx4 v242, s[20:23], s58 offen lds
    s_add_u32 m0, s56, 16672
    s_nop 0
    buffer_load_dwordx4 v242, s[20:23], s58 offen offset:1280 lds
    s_add_u32 m0, s56, 16448
    s_nop 0
    buffer_load_dwordx4 v242, s[20:23], s58 offen offset:2560 lds
    s_add_u32 m0, s56, 16224
    s_nop 0
    buffer_load_dwordx4 v242, s[20:23], s58 offen offset:3840 lds
    s_add_u32 s58, s58, 128
    s_cmp_eq_u32 s58, 1280
    s_cselect_b32 s58, 0, s58
    s_add_u32 m0, s44, 129024
    s_nop 0
    buffer_load_dwordx4 v240, s[32:35], s57 offen lds
    s_add_u32 m0, s44, 130112
    s_nop 0
    buffer_load_dwordx4 v241, s[32:35], s57 offen lds
    s_add_u32 s57, s57, 262144
    s_waitcnt vmcnt(12)
    s_barrier
    s_add_u32 m0, s44, 137728
    s_nop 0
    buffer_load_dwordx4 v240, s[32:35], s57 offen lds
    s_add_u32 m0, s44, 138816
    s_nop 0
    buffer_load_dwordx4 v241, s[32:35], s57 offen lds
    s_add_u32 s57, s57, 262144
    s_and_b32 s69, s57, 256
    s_cmp_ge_u32 s57, 5242880
    s_cselect_b32 s57, s69, s57
    ds_read_b128 v[128:131], v239 offset:0
    ds_read_b128 v[132:135], v239 offset:32
    ds_read_b128 v[136:139], v239 offset:64
    ds_read_b128 v[140:143], v239 offset:96
    s_waitcnt vmcnt(10) lgkmcnt(0)
    s_barrier
    s_add_u32 m0, s56, 0
    s_nop 0
    buffer_load_dwordx4 v242, s[20:23], s58 offen lds
    s_add_u32 m0, s56, -224
    s_nop 0
    buffer_load_dwordx4 v242, s[20:23], s58 offen offset:1280 lds
    s_add_u32 m0, s56, -448
    s_nop 0
    buffer_load_dwordx4 v242, s[20:23], s58 offen offset:2560 lds
    s_add_u32 m0, s56, -672
    s_nop 0
    buffer_load_dwordx4 v242, s[20:23], s58 offen offset:3840 lds
    s_add_u32 s58, s58, 128
    s_cmp_eq_u32 s58, 1280
    s_cselect_b32 s58, 0, s58
    s_xor_b32 s47, s57, 256
    s_add_u32 m0, s44, 146432
    s_nop 0
    buffer_load_dwordx4 v240, s[32:35], s57 offen lds
    s_add_u32 m0, s44, 147520
    s_nop 0
    buffer_load_dwordx4 v241, s[32:35], s57 offen lds
    s_add_u32 s57, s57, 262144
    s_waitcnt vmcnt(8)
    s_barrier
    s_add_u32 m0, s44, 155136
    s_nop 0
    buffer_load_dwordx4 v240, s[32:35], s57 offen lds
    s_add_u32 m0, s44, 156224
    s_nop 0
    buffer_load_dwordx4 v241, s[32:35], s57 offen lds
    s_add_u32 s57, s57, 262144
    s_and_b32 s69, s57, 256
    s_cmp_ge_u32 s57, 5242880
    s_cselect_b32 s57, s69, s57
    ds_read_b128 v[112:115], v239 offset:16896
    ds_read_b128 v[116:119], v239 offset:16928
    ds_read_b128 v[120:123], v239 offset:16960
    ds_read_b128 v[124:127], v239 offset:16992
    s_waitcnt vmcnt(8) lgkmcnt(0)
    s_barrier
    s_add_u32 m0, s56, 16896
    s_nop 0
    buffer_load_dwordx4 v242, s[20:23], s58 offen lds
    s_add_u32 m0, s56, 16672
    s_nop 0
    buffer_load_dwordx4 v242, s[20:23], s58 offen offset:1280 lds
    s_add_u32 m0, s56, 16448
    s_nop 0
    buffer_load_dwordx4 v242, s[20:23], s58 offen offset:2560 lds
    s_add_u32 m0, s56, 16224
    s_nop 0
    buffer_load_dwordx4 v242, s[20:23], s58 offen offset:3840 lds
    s_add_u32 s58, s58, 128
    s_cmp_eq_u32 s58, 1280
    s_cselect_b32 s58, 0, s58
    s_add_u32 m0, s44, 129024
    s_nop 0
    buffer_load_dwordx4 v240, s[32:35], s57 offen lds
    s_add_u32 m0, s44, 130112
    s_nop 0
    buffer_load_dwordx4 v241, s[32:35], s57 offen lds
    s_add_u32 s57, s57, 262144
    s_waitcnt vmcnt(8)
    s_barrier
    s_add_u32 m0, s44, 137728
    s_nop 0
    buffer_load_dwordx4 v240, s[32:35], s57 offen lds
    s_add_u32 m0, s44, 138816
    s_nop 0
    buffer_load_dwordx4 v241, s[32:35], s57 offen lds
    s_mov_b32 s57, s47
    s_waitcnt vmcnt(8)
    s_barrier
    s_add_u32 m0, s44, 146432
    s_nop 0
    buffer_load_dwordx4 v240, s[32:35], s57 offen lds
    s_add_u32 m0, s44, 147520
    s_nop 0
    buffer_load_dwordx4 v241, s[32:35], s57 offen lds
    s_add_u32 s57, s57, 262144
    s_waitcnt vmcnt(4)
    s_barrier
    s_add_u32 m0, s44, 155136
    s_nop 0
    buffer_load_dwordx4 v240, s[32:35], s57 offen lds
    s_add_u32 m0, s44, 156224
    s_nop 0
    buffer_load_dwordx4 v241, s[32:35], s57 offen lds
    s_add_u32 s57, s57, 262144
    s_and_b32 s69, s57, 256
    s_cmp_ge_u32 s57, 5242880
    s_cselect_b32 s57, s69, s57
    s_waitcnt vmcnt(4)
    s_barrier
    s_add_u32 m0, s44, 129024
    s_nop 0
    buffer_load_dwordx4 v240, s[32:35], s57 offen lds
    s_add_u32 m0, s44, 130112
    s_nop 0
    buffer_load_dwordx4 v241, s[32:35], s57 offen lds
    s_add_u32 s57, s57, 262144
    s_barrier
    s_add_u32 m0, s44, 137728
    s_nop 0
    buffer_load_dwordx4 v240, s[32:35], s57 offen lds
    s_add_u32 m0, s44, 138816
    s_nop 0
    buffer_load_dwordx4 v241, s[32:35], s57 offen lds
    s_add_u32 s57, s57, 262144
    s_and_b32 s69, s57, 256
    s_cmp_ge_u32 s57, 5242880
    s_cselect_b32 s57, s69, s57
    v_subrev_u32 v242, 81920, v238
    s_lshl_b32 s51, s49, 5
    s_add_u32 s51, s51, s50
    s_sub_u32 s51, s51, s68
    s_lshl_b32 s51, s51, 17
    s_add_u32 s24, s6, s51
    s_addc_u32 s25, s7, 0
    s_mov_b32 s26, 131072
    s_mov_b32 s27, 0x20000
    s_add_u32 s28, s8, s51
    s_addc_u32 s29, s9, 0
    s_mov_b32 s30, 131072
    s_mov_b32 s31, 0x20000
    s_add_u32 s54, s54, 81920
    s_add_u32 s55, s55, 81920
    s_mov_b32 s59, s67
    s_mov_b32 s60, s67
    s_waitcnt vmcnt(4)
    s_barrier
    ds_read_b128 v[224:227], v239 offset:0
    ds_read_b128 v[228:231], v239 offset:32
    s_add_u32 m0, s44, 33792
    ds_read_b64_tr_b16 v[192:193], v238 offset:30720
    ds_read_b64_tr_b16 v[194:195], v238 offset:35072
    ds_read_b64_tr_b16 v[196:197], v238 offset:30784
    ds_read_b64_tr_b16 v[198:199], v238 offset:35136
    buffer_load_dwordx4 v240, s[32:35], s57 offen lds
    s_add_u32 m0, s44, 34880
    ds_read_b64_tr_b16 v[200:201], v238 offset:30848
    ds_read_b64_tr_b16 v[202:203], v238 offset:35200
    ds_read_b64_tr_b16 v[204:205], v238 offset:30912
    ds_read_b64_tr_b16 v[206:207], v238 offset:35264
    buffer_load_dwordx4 v241, s[32:35], s57 offen lds
    s_add_u32 s57, s57, 262144
    s_add_u32 m0, s44, 115712
    ds_read_b64_tr_b16 v[208:209], v238 offset:31232
    ds_read_b64_tr_b16 v[210:211], v238 offset:35584
    ds_read_b64_tr_b16 v[212:213], v238 offset:31296
    ds_read_b64_tr_b16 v[214:215], v238 offset:35648
    buffer_load_dwordx4 v240, s[32:35], s57 offen lds
    s_add_u32 m0, s44, 116800
    ds_read_b64_tr_b16 v[216:217], v238 offset:31360
    ds_read_b64_tr_b16 v[218:219], v238 offset:35712
    ds_read_b64_tr_b16 v[220:221], v238 offset:31424
    ds_read_b64_tr_b16 v[222:223], v238 offset:35776
    buffer_load_dwordx4 v241, s[32:35], s57 offen lds
    s_add_u32 s57, s57, 262144
    s_and_b32 s69, s57, 256
    s_cmp_ge_u32 s57, 5242880
    s_cselect_b32 s57, s69, s57
    s_waitcnt lgkmcnt(14)
    v_mfma_f32_32x32x16_bf16 v[0:15], v[192:195], v[224:227], v[0:15]
    ds_read_b64_tr_b16 v[192:193], v238 offset:39424
    ds_read_b64_tr_b16 v[194:195], v238 offset:43776
    s_waitcnt lgkmcnt(14)
    v_mfma_f32_32x32x16_bf16 v[16:31], v[196:199], v[224:227], v[16:31]
    ds_read_b64_tr_b16 v[196:197], v238 offset:39488
    ds_read_b64_tr_b16 v[198:199], v238 offset:43840
    s_waitcnt lgkmcnt(14)
    v_mfma_f32_32x32x16_bf16 v[32:47], v[200:203], v[224:227], v[32:47]
    ds_read_b64_tr_b16 v[200:201], v238 offset:39552
    ds_read_b64_tr_b16 v[202:203], v238 offset:43904
    s_waitcnt lgkmcnt(14)
    v_mfma_f32_32x32x16_bf16 v[48:63], v[204:207], v[224:227], v[48:63]
    ds_read_b64_tr_b16 v[204:205], v238 offset:39616
    ds_read_b64_tr_b16 v[206:207], v238 offset:43968
    ds_read_b128 v[224:227], v239 offset:64
    s_waitcnt lgkmcnt(15)
    v_mfma_f32_32x32x16_bf16 v[0:15], v[208:211], v[228:231], v[0:15]
    ds_read_b64_tr_b16 v[208:209], v238 offset:39936
    ds_read_b64_tr_b16 v[210:211], v238 offset:44288
    s_waitcnt lgkmcnt(15)
    v_mfma_f32_32x32x16_bf16 v[16:31], v[212:215], v[228:231], v[16:31]
    ds_read_b64_tr_b16 v[212:213], v238 offset:40000
    ds_read_b64_tr_b16 v[214:215], v238 offset:44352
    s_waitcnt lgkmcnt(15)
    v_mfma_f32_32x32x16_bf16 v[32:47], v[216:219], v[228:231], v[32:47]
    ds_read_b64_tr_b16 v[216:217], v238 offset:40064
    ds_read_b64_tr_b16 v[218:219], v238 offset:44416
    s_waitcnt lgkmcnt(15)
    v_mfma_f32_32x32x16_bf16 v[48:63], v[220:223], v[228:231], v[48:63]
    ds_read_b64_tr_b16 v[220:221], v238 offset:40128
    ds_read_b64_tr_b16 v[222:223], v238 offset:44480
    ds_read_b128 v[228:231], v239 offset:96
    s_waitcnt lgkmcnt(9)
    v_mfma_f32_32x32x16_bf16 v[0:15], v[192:195], v[224:227], v[0:15]
    v_mfma_f32_32x32x16_bf16 v[16:31], v[196:199], v[224:227], v[16:31]
    v_mfma_f32_32x32x16_bf16 v[32:47], v[200:203], v[224:227], v[32:47]
    v_mfma_f32_32x32x16_bf16 v[48:63], v[204:207], v[224:227], v[48:63]
    s_waitcnt lgkmcnt(0)
    v_mfma_f32_32x32x16_bf16 v[0:15], v[208:211], v[228:231], v[0:15]
    v_mfma_f32_32x32x16_bf16 v[16:31], v[212:215], v[228:231], v[16:31]
    v_mfma_f32_32x32x16_bf16 v[32:47], v[216:219], v[228:231], v[32:47]
    v_mfma_f32_32x32x16_bf16 v[48:63], v[220:223], v[228:231], v[48:63]
    s_waitcnt vmcnt(4)
    s_barrier
    ds_read_b128 v[224:227], v239 offset:16896
    ds_read_b128 v[228:231], v239 offset:16928
    s_add_u32 m0, s44, 146432
    ds_read_b64_tr_b16 v[192:193], v238 offset:13312
    ds_read_b64_tr_b16 v[194:195], v238 offset:17664
    ds_read_b64_tr_b16 v[196:197], v238 offset:13376
    ds_read_b64_tr_b16 v[198:199], v238 offset:17728
    buffer_load_dwordx4 v240, s[32:35], s57 offen lds
    s_add_u32 m0, s44, 147520
    ds_read_b64_tr_b16 v[200:201], v238 offset:13440
    ds_read_b64_tr_b16 v[202:203], v238 offset:17792
    ds_read_b64_tr_b16 v[204:205], v238 offset:13504
    ds_read_b64_tr_b16 v[206:207], v238 offset:17856
    buffer_load_dwordx4 v241, s[32:35], s57 offen lds
    s_add_u32 s57, s57, 262144
    s_add_u32 m0, s44, 155136
    ds_read_b64_tr_b16 v[208:209], v238 offset:13824
    ds_read_b64_tr_b16 v[210:211], v238 offset:18176
    ds_read_b64_tr_b16 v[212:213], v238 offset:13888
    ds_read_b64_tr_b16 v[214:215], v238 offset:18240
    buffer_load_dwordx4 v240, s[32:35], s57 offen lds
    s_add_u32 m0, s44, 156224
    ds_read_b64_tr_b16 v[216:217], v238 offset:13952
    ds_read_b64_tr_b16 v[218:219], v238 offset:18304
    ds_read_b64_tr_b16 v[220:221], v238 offset:14016
    ds_read_b64_tr_b16 v[222:223], v238 offset:18368
    buffer_load_dwordx4 v241, s[32:35], s57 offen lds
    s_add_u32 s57, s57, 262144
    s_and_b32 s69, s57, 256
    s_cmp_ge_u32 s57, 5242880
    s_cselect_b32 s57, s69, s57
    s_waitcnt lgkmcnt(14)
    v_mfma_f32_32x32x16_bf16 v[0:15], v[192:195], v[224:227], v[0:15]
    ds_read_b64_tr_b16 v[192:193], v238 offset:22016
    ds_read_b64_tr_b16 v[194:195], v238 offset:26368
    s_waitcnt lgkmcnt(14)
    v_mfma_f32_32x32x16_bf16 v[16:31], v[196:199], v[224:227], v[16:31]
    ds_read_b64_tr_b16 v[196:197], v238 offset:22080
    ds_read_b64_tr_b16 v[198:199], v238 offset:26432
    s_waitcnt lgkmcnt(14)
    v_mfma_f32_32x32x16_bf16 v[32:47], v[200:203], v[224:227], v[32:47]
    ds_read_b64_tr_b16 v[200:201], v238 offset:22144
    ds_read_b64_tr_b16 v[202:203], v238 offset:26496
    s_waitcnt lgkmcnt(14)
    v_mfma_f32_32x32x16_bf16 v[48:63], v[204:207], v[224:227], v[48:63]
    ds_read_b64_tr_b16 v[204:205], v238 offset:22208
    ds_read_b64_tr_b16 v[206:207], v238 offset:26560
    ds_read_b128 v[224:227], v239 offset:16960
    s_waitcnt lgkmcnt(15)
    v_mfma_f32_32x32x16_bf16 v[0:15], v[208:211], v[228:231], v[0:15]
    ds_read_b64_tr_b16 v[208:209], v238 offset:22528
    ds_read_b64_tr_b16 v[210:211], v238 offset:26880
    s_waitcnt lgkmcnt(15)
    v_mfma_f32_32x32x16_bf16 v[16:31], v[212:215], v[228:231], v[16:31]
    ds_read_b64_tr_b16 v[212:213], v238 offset:22592
    ds_read_b64_tr_b16 v[214:215], v238 offset:26944
    s_waitcnt lgkmcnt(15)
    v_mfma_f32_32x32x16_bf16 v[32:47], v[216:219], v[228:231], v[32:47]
    ds_read_b64_tr_b16 v[216:217], v238 offset:22656
    ds_read_b64_tr_b16 v[218:219], v238 offset:27008
    s_waitcnt lgkmcnt(15)
    v_mfma_f32_32x32x16_bf16 v[48:63], v[220:223], v[228:231], v[48:63]
    ds_read_b64_tr_b16 v[220:221], v238 offset:22720
    ds_read_b64_tr_b16 v[222:223], v238 offset:27072
    ds_read_b128 v[228:231], v239 offset:16992
    s_waitcnt lgkmcnt(9)
    v_mfma_f32_32x32x16_bf16 v[0:15], v[192:195], v[224:227], v[0:15]
    v_mfma_f32_32x32x16_bf16 v[16:31], v[196:199], v[224:227], v[16:31]
    v_mfma_f32_32x32x16_bf16 v[32:47], v[200:203], v[224:227], v[32:47]
    v_mfma_f32_32x32x16_bf16 v[48:63], v[204:207], v[224:227], v[48:63]
    s_waitcnt lgkmcnt(0)
    v_mfma_f32_32x32x16_bf16 v[0:15], v[208:211], v[228:231], v[0:15]
    v_mfma_f32_32x32x16_bf16 v[16:31], v[212:215], v[228:231], v[16:31]
    v_mfma_f32_32x32x16_bf16 v[32:47], v[216:219], v[228:231], v[32:47]
    v_mfma_f32_32x32x16_bf16 v[48:63], v[220:223], v[228:231], v[48:63]
    s_waitcnt vmcnt(4)
    s_barrier
    s_add_u32 m0, s44, 129024
    ds_read_b64_tr_b16 v[192:193], v242 offset:0
    ds_read_b64_tr_b16 v[194:195], v242 offset:4352
    ds_read_b64_tr_b16 v[196:197], v242 offset:64
    ds_read_b64_tr_b16 v[198:199], v242 offset:4416
    buffer_load_dwordx4 v240, s[32:35], s57 offen lds
    s_add_u32 m0, s44, 130112
    ds_read_b64_tr_b16 v[200:201], v242 offset:128
    ds_read_b64_tr_b16 v[202:203], v242 offset:4480
    ds_read_b64_tr_b16 v[204:205], v242 offset:192
    ds_read_b64_tr_b16 v[206:207], v242 offset:4544
    buffer_load_dwordx4 v241, s[32:35], s57 offen lds
    s_add_u32 s57, s57, 262144
    s_add_u32 m0, s44, 137728
    ds_read_b64_tr_b16 v[208:209], v242 offset:512
    ds_read_b64_tr_b16 v[210:211], v242 offset:4864
    ds_read_b64_tr_b16 v[212:213], v242 offset:576
    ds_read_b64_tr_b16 v[214:215], v242 offset:4928
    buffer_load_dwordx4 v240, s[32:35], s57 offen lds
    s_add_u32 m0, s44, 138816
    ds_read_b64_tr_b16 v[216:217], v242 offset:640
    ds_read_b64_tr_b16 v[218:219], v242 offset:4992
    ds_read_b64_tr_b16 v[220:221], v242 offset:704
    ds_read_b64_tr_b16 v[222:223], v242 offset:5056
    buffer_load_dwordx4 v241, s[32:35], s57 offen lds
    s_add_u32 s57, s57, 262144
    s_and_b32 s69, s57, 256
    s_cmp_ge_u32 s57, 5242880
    s_cselect_b32 s57, s69, s57
    s_waitcnt lgkmcnt(14)
    v_mfma_f32_32x32x16_bf16 v[0:15], v[192:195], v[64:67], v[0:15]
    ds_read_b64_tr_b16 v[192:193], v238 offset:0
    ds_read_b64_tr_b16 v[194:195], v238 offset:4352
    s_waitcnt lgkmcnt(14)
    v_mfma_f32_32x32x16_bf16 v[16:31], v[196:199], v[64:67], v[16:31]
    ds_read_b64_tr_b16 v[196:197], v238 offset:64
    ds_read_b64_tr_b16 v[198:199], v238 offset:4416
    s_waitcnt lgkmcnt(14)
    v_mfma_f32_32x32x16_bf16 v[32:47], v[200:203], v[64:67], v[32:47]
    ds_read_b64_tr_b16 v[200:201], v238 offset:128
    ds_read_b64_tr_b16 v[202:203], v238 offset:4480
    s_waitcnt lgkmcnt(14)
    v_mfma_f32_32x32x16_bf16 v[48:63], v[204:207], v[64:67], v[48:63]
    ds_read_b64_tr_b16 v[204:205], v238 offset:192
    ds_read_b64_tr_b16 v[206:207], v238 offset:4544
    s_waitcnt lgkmcnt(14)
    v_mfma_f32_32x32x16_bf16 v[0:15], v[208:211], v[68:71], v[0:15]
    ds_read_b64_tr_b16 v[208:209], v238 offset:512
    ds_read_b64_tr_b16 v[210:211], v238 offset:4864
    s_waitcnt lgkmcnt(14)
    v_mfma_f32_32x32x16_bf16 v[16:31], v[212:215], v[68:71], v[16:31]
    ds_read_b64_tr_b16 v[212:213], v238 offset:576
    ds_read_b64_tr_b16 v[214:215], v238 offset:4928
    s_waitcnt lgkmcnt(14)
    v_mfma_f32_32x32x16_bf16 v[32:47], v[216:219], v[68:71], v[32:47]
    ds_read_b64_tr_b16 v[216:217], v238 offset:640
    ds_read_b64_tr_b16 v[218:219], v238 offset:4992
    s_waitcnt lgkmcnt(14)
    v_mfma_f32_32x32x16_bf16 v[48:63], v[220:223], v[68:71], v[48:63]
    ds_read_b64_tr_b16 v[220:221], v238 offset:704
    ds_read_b64_tr_b16 v[222:223], v238 offset:5056
    s_waitcnt lgkmcnt(14)
    v_mfma_f32_32x32x16_bf16 v[0:15], v[192:195], v[72:75], v[0:15]
    s_waitcnt lgkmcnt(12)
    v_mfma_f32_32x32x16_bf16 v[16:31], v[196:199], v[72:75], v[16:31]
    s_waitcnt lgkmcnt(10)
    v_mfma_f32_32x32x16_bf16 v[32:47], v[200:203], v[72:75], v[32:47]
    s_waitcnt lgkmcnt(8)
    v_mfma_f32_32x32x16_bf16 v[48:63], v[204:207], v[72:75], v[48:63]
    s_waitcnt lgkmcnt(6)
    v_mfma_f32_32x32x16_bf16 v[0:15], v[208:211], v[76:79], v[0:15]
    s_waitcnt lgkmcnt(4)
    v_mfma_f32_32x32x16_bf16 v[16:31], v[212:215], v[76:79], v[16:31]
    s_waitcnt lgkmcnt(2)
    v_mfma_f32_32x32x16_bf16 v[32:47], v[216:219], v[76:79], v[32:47]
    s_waitcnt lgkmcnt(0)
    v_mfma_f32_32x32x16_bf16 v[48:63], v[220:223], v[76:79], v[48:63]
    s_waitcnt vmcnt(4)
    s_barrier
    s_add_u32 m0, s44, 33792
    ds_read_b64_tr_b16 v[192:193], v238 offset:30720
    ds_read_b64_tr_b16 v[194:195], v238 offset:35072
    ds_read_b64_tr_b16 v[196:197], v238 offset:30784
    ds_read_b64_tr_b16 v[198:199], v238 offset:35136
    buffer_load_dwordx4 v240, s[32:35], s57 offen lds
    s_add_u32 m0, s44, 34880
    ds_read_b64_tr_b16 v[200:201], v238 offset:30848
    ds_read_b64_tr_b16 v[202:203], v238 offset:35200
    ds_read_b64_tr_b16 v[204:205], v238 offset:30912
    ds_read_b64_tr_b16 v[206:207], v238 offset:35264
    buffer_load_dwordx4 v241, s[32:35], s57 offen lds
    s_add_u32 s57, s57, 262144
    s_add_u32 m0, s44, 115712
    ds_read_b64_tr_b16 v[208:209], v238 offset:31232
    ds_read_b64_tr_b16 v[210:211], v238 offset:35584
    ds_read_b64_tr_b16 v[212:213], v238 offset:31296
    ds_read_b64_tr_b16 v[214:215], v238 offset:35648
    buffer_load_dwordx4 v240, s[32:35], s57 offen lds
    s_add_u32 m0, s44, 116800
    ds_read_b64_tr_b16 v[216:217], v238 offset:31360
    ds_read_b64_tr_b16 v[218:219], v238 offset:35712
    ds_read_b64_tr_b16 v[220:221], v238 offset:31424
    ds_read_b64_tr_b16 v[222:223], v238 offset:35776
    buffer_load_dwordx4 v241, s[32:35], s57 offen lds
    s_add_u32 s57, s57, 262144
    s_and_b32 s69, s57, 256
    s_cmp_ge_u32 s57, 5242880
    s_cselect_b32 s57, s69, s57
    s_waitcnt lgkmcnt(14)
    v_mfma_f32_32x32x16_bf16 v[0:15], v[192:195], v[80:83], v[0:15]
    ds_read_b64_tr_b16 v[192:193], v238 offset:39424
    ds_read_b64_tr_b16 v[194:195], v238 offset:43776
    s_waitcnt lgkmcnt(14)
    v_mfma_f32_32x32x16_bf16 v[16:31], v[196:199], v[80:83], v[16:31]
    ds_read_b64_tr_b16 v[196:197], v238 offset:39488
    ds_read_b64_tr_b16 v[198:199], v238 offset:43840
    s_waitcnt lgkmcnt(14)
    v_mfma_f32_32x32x16_bf16 v[32:47], v[200:203], v[80:83], v[32:47]
    ds_read_b64_tr_b16 v[200:201], v238 offset:39552
    ds_read_b64_tr_b16 v[202:203], v238 offset:43904
    s_waitcnt lgkmcnt(14)
    v_mfma_f32_32x32x16_bf16 v[48:63], v[204:207], v[80:83], v[48:63]
    ds_read_b64_tr_b16 v[204:205], v238 offset:39616
    ds_read_b64_tr_b16 v[206:207], v238 offset:43968
    s_add_u32 m0, s54, 0
    s_waitcnt lgkmcnt(14)
    v_mfma_f32_32x32x16_bf16 v[0:15], v[208:211], v[84:87], v[0:15]
    ds_read_b64_tr_b16 v[208:209], v238 offset:39936
    ds_read_b64_tr_b16 v[210:211], v238 offset:44288
    buffer_load_dwordx4 v236, s[24:27], s59 offen nt lds
    s_waitcnt lgkmcnt(14)
    v_mfma_f32_32x32x16_bf16 v[16:31], v[212:215], v[84:87], v[16:31]
    ds_read_b64_tr_b16 v[212:213], v238 offset:40000
    ds_read_b64_tr_b16 v[214:215], v238 offset:44352
    s_add_u32 m0, s54, 800
    s_waitcnt lgkmcnt(14)
    v_mfma_f32_32x32x16_bf16 v[32:47], v[216:219], v[84:87], v[32:47]
    ds_read_b64_tr_b16 v[216:217], v238 offset:40064
    ds_read_b64_tr_b16 v[218:219], v238 offset:44416
    buffer_load_dwordx4 v236, s[24:27], s59 offen offset:256 nt lds
    s_add_u32 s59, s59, 8192
    s_and_b32 s59, s59, 0x1ffff
    s_waitcnt lgkmcnt(14)
    v_mfma_f32_32x32x16_bf16 v[48:63], v[220:223], v[84:87], v[48:63]
    ds_read_b64_tr_b16 v[220:221], v238 offset:40128
    ds_read_b64_tr_b16 v[222:223], v238 offset:44480
    s_waitcnt lgkmcnt(14)
    v_mfma_f32_32x32x16_bf16 v[0:15], v[192:195], v[88:91], v[0:15]
    s_waitcnt lgkmcnt(12)
    v_mfma_f32_32x32x16_bf16 v[16:31], v[196:199], v[88:91], v[16:31]
    s_waitcnt lgkmcnt(10)
    v_mfma_f32_32x32x16_bf16 v[32:47], v[200:203], v[88:91], v[32:47]
    s_waitcnt lgkmcnt(8)
    v_mfma_f32_32x32x16_bf16 v[48:63], v[204:207], v[88:91], v[48:63]
    s_waitcnt lgkmcnt(6)
    v_mfma_f32_32x32x16_bf16 v[0:15], v[208:211], v[92:95], v[0:15]
    s_waitcnt lgkmcnt(4)
    v_mfma_f32_32x32x16_bf16 v[16:31], v[212:215], v[92:95], v[16:31]
    s_waitcnt lgkmcnt(2)
    v_mfma_f32_32x32x16_bf16 v[32:47], v[216:219], v[92:95], v[32:47]
    s_waitcnt lgkmcnt(0)
    v_mfma_f32_32x32x16_bf16 v[48:63], v[220:223], v[92:95], v[48:63]
    s_waitcnt vmcnt(6)
    s_barrier
    s_add_u32 m0, s44, 146432
    ds_read_b64_tr_b16 v[192:193], v238 offset:13312
    ds_read_b64_tr_b16 v[194:195], v238 offset:17664
    ds_read_b64_tr_b16 v[196:197], v238 offset:13376
    ds_read_b64_tr_b16 v[198:199], v238 offset:17728
    buffer_load_dwordx4 v240, s[32:35], s57 offen lds
    s_add_u32 m0, s44, 147520
    ds_read_b64_tr_b16 v[200:201], v238 offset:13440
    ds_read_b64_tr_b16 v[202:203], v238 offset:17792
    ds_read_b64_tr_b16 v[204:205], v238 offset:13504
    ds_read_b64_tr_b16 v[206:207], v238 offset:17856
    buffer_load_dwordx4 v241, s[32:35], s57 offen lds
    s_add_u32 s57, s57, 262144
    s_add_u32 m0, s44, 155136
    ds_read_b64_tr_b16 v[208:209], v238 offset:13824
    ds_read_b64_tr_b16 v[210:211], v238 offset:18176
    ds_read_b64_tr_b16 v[212:213], v238 offset:13888
    ds_read_b64_tr_b16 v[214:215], v238 offset:18240
    buffer_load_dwordx4 v240, s[32:35], s57 offen lds
    s_add_u32 m0, s44, 156224
    ds_read_b64_tr_b16 v[216:217], v238 offset:13952
    ds_read_b64_tr_b16 v[218:219], v238 offset:18304
    ds_read_b64_tr_b16 v[220:221], v238 offset:14016
    ds_read_b64_tr_b16 v[222:223], v238 offset:18368
    buffer_load_dwordx4 v241, s[32:35], s57 offen lds
    s_add_u32 s57, s57, 262144
    s_and_b32 s69, s57, 256
    s_cmp_ge_u32 s57, 5242880
    s_cselect_b32 s57, s69, s57
    s_waitcnt lgkmcnt(14)
    v_mfma_f32_32x32x16_bf16 v[0:15], v[192:195], v[96:99], v[0:15]
    ds_read_b64_tr_b16 v[192:193], v238 offset:22016
    ds_read_b64_tr_b16 v[194:195], v238 offset:26368
    s_waitcnt lgkmcnt(14)
    v_mfma_f32_32x32x16_bf16 v[16:31], v[196:199], v[96:99], v[16:31]
    ds_read_b64_tr_b16 v[196:197], v238 offset:22080
    ds_read_b64_tr_b16 v[198:199], v238 offset:26432
    s_waitcnt lgkmcnt(14)
    v_mfma_f32_32x32x16_bf16 v[32:47], v[200:203], v[96:99], v[32:47]
    ds_read_b64_tr_b16 v[200:201], v238 offset:22144
    ds_read_b64_tr_b16 v[202:203], v238 offset:26496
    s_waitcnt lgkmcnt(14)
    v_mfma_f32_32x32x16_bf16 v[48:63], v[204:207], v[96:99], v[48:63]
    ds_read_b64_tr_b16 v[204:205], v238 offset:22208
    ds_read_b64_tr_b16 v[206:207], v238 offset:26560
    s_add_u32 m0, s54, 8448
    s_waitcnt lgkmcnt(14)
    v_mfma_f32_32x32x16_bf16 v[0:15], v[208:211], v[100:103], v[0:15]
    ds_read_b64_tr_b16 v[208:209], v238 offset:22528
    ds_read_b64_tr_b16 v[210:211], v238 offset:26880
    buffer_load_dwordx4 v236, s[24:27], s59 offen nt lds
    s_waitcnt lgkmcnt(14)
    v_mfma_f32_32x32x16_bf16 v[16:31], v[212:215], v[100:103], v[16:31]
    ds_read_b64_tr_b16 v[212:213], v238 offset:22592
    ds_read_b64_tr_b16 v[214:215], v238 offset:26944
    s_add_u32 m0, s54, 9248
    s_waitcnt lgkmcnt(14)
    v_mfma_f32_32x32x16_bf16 v[32:47], v[216:219], v[100:103], v[32:47]
    ds_read_b64_tr_b16 v[216:217], v238 offset:22656
    ds_read_b64_tr_b16 v[218:219], v238 offset:27008
    buffer_load_dwordx4 v236, s[24:27], s59 offen offset:256 nt lds
    s_add_u32 s59, s59, 8192
    s_and_b32 s59, s59, 0x1ffff
    s_waitcnt lgkmcnt(14)
    v_mfma_f32_32x32x16_bf16 v[48:63], v[220:223], v[100:103], v[48:63]
    ds_read_b64_tr_b16 v[220:221], v238 offset:22720
    ds_read_b64_tr_b16 v[222:223], v238 offset:27072
    s_waitcnt lgkmcnt(14)
    v_mfma_f32_32x32x16_bf16 v[0:15], v[192:195], v[104:107], v[0:15]
    s_waitcnt lgkmcnt(12)
    v_mfma_f32_32x32x16_bf16 v[16:31], v[196:199], v[104:107], v[16:31]
    s_waitcnt lgkmcnt(10)
    v_mfma_f32_32x32x16_bf16 v[32:47], v[200:203], v[104:107], v[32:47]
    s_waitcnt lgkmcnt(8)
    v_mfma_f32_32x32x16_bf16 v[48:63], v[204:207], v[104:107], v[48:63]
    s_waitcnt lgkmcnt(6)
    v_mfma_f32_32x32x16_bf16 v[0:15], v[208:211], v[108:111], v[0:15]
    s_waitcnt lgkmcnt(4)
    v_mfma_f32_32x32x16_bf16 v[16:31], v[212:215], v[108:111], v[16:31]
    s_waitcnt lgkmcnt(2)
    v_mfma_f32_32x32x16_bf16 v[32:47], v[216:219], v[108:111], v[32:47]
    s_waitcnt lgkmcnt(0)
    v_mfma_f32_32x32x16_bf16 v[48:63], v[220:223], v[108:111], v[48:63]
    s_waitcnt vmcnt(8)
    s_barrier
    s_add_u32 m0, s44, 129024
    ds_read_b64_tr_b16 v[192:193], v242 offset:0
    ds_read_b64_tr_b16 v[194:195], v242 offset:4352
    ds_read_b64_tr_b16 v[196:197], v242 offset:64
    ds_read_b64_tr_b16 v[198:199], v242 offset:4416
    buffer_load_dwordx4 v240, s[32:35], s57 offen lds
    s_add_u32 m0, s44, 130112
    ds_read_b64_tr_b16 v[200:201], v242 offset:128
    ds_read_b64_tr_b16 v[202:203], v242 offset:4480
    ds_read_b64_tr_b16 v[204:205], v242 offset:192
    ds_read_b64_tr_b16 v[206:207], v242 offset:4544
    buffer_load_dwordx4 v241, s[32:35], s57 offen lds
    s_add_u32 s57, s57, 262144
    s_add_u32 m0, s44, 137728
    ds_read_b64_tr_b16 v[208:209], v242 offset:512
    ds_read_b64_tr_b16 v[210:211], v242 offset:4864
    ds_read_b64_tr_b16 v[212:213], v242 offset:576
    ds_read_b64_tr_b16 v[214:215], v242 offset:4928
    buffer_load_dwordx4 v240, s[32:35], s57 offen lds
    s_add_u32 m0, s44, 138816
    ds_read_b64_tr_b16 v[216:217], v242 offset:640
    ds_read_b64_tr_b16 v[218:219], v242 offset:4992
    ds_read_b64_tr_b16 v[220:221], v242 offset:704
    ds_read_b64_tr_b16 v[222:223], v242 offset:5056
    buffer_load_dwordx4 v241, s[32:35], s57 offen lds
    s_add_u32 s57, s57, 262144
    s_and_b32 s69, s57, 256
    s_cmp_ge_u32 s57, 5242880
    s_cselect_b32 s57, s69, s57
    s_waitcnt lgkmcnt(14)
    v_mfma_f32_32x32x16_bf16 v[0:15], v[192:195], v[144:147], v[0:15]
    ds_read_b64_tr_b16 v[192:193], v238 offset:0
    ds_read_b64_tr_b16 v[194:195], v238 offset:4352
    s_waitcnt lgkmcnt(14)
    v_mfma_f32_32x32x16_bf16 v[16:31], v[196:199], v[144:147], v[16:31]
    ds_read_b64_tr_b16 v[196:197], v238 offset:64
    ds_read_b64_tr_b16 v[198:199], v238 offset:4416
    s_waitcnt lgkmcnt(14)
    v_mfma_f32_32x32x16_bf16 v[32:47], v[200:203], v[144:147], v[32:47]
    ds_read_b64_tr_b16 v[200:201], v238 offset:128
    ds_read_b64_tr_b16 v[202:203], v238 offset:4480
    s_waitcnt lgkmcnt(14)
    v_mfma_f32_32x32x16_bf16 v[48:63], v[204:207], v[144:147], v[48:63]
    ds_read_b64_tr_b16 v[204:205], v238 offset:192
    ds_read_b64_tr_b16 v[206:207], v238 offset:4544
    s_add_u32 m0, s54, 16896
    s_waitcnt lgkmcnt(14)
    v_mfma_f32_32x32x16_bf16 v[0:15], v[208:211], v[148:151], v[0:15]
    ds_read_b64_tr_b16 v[208:209], v238 offset:512
    ds_read_b64_tr_b16 v[210:211], v238 offset:4864
    buffer_load_dwordx4 v236, s[24:27], s59 offen nt lds
    s_waitcnt lgkmcnt(14)
    v_mfma_f32_32x32x16_bf16 v[16:31], v[212:215], v[148:151], v[16:31]
    ds_read_b64_tr_b16 v[212:213], v238 offset:576
    ds_read_b64_tr_b16 v[214:215], v238 offset:4928
    s_add_u32 m0, s54, 17696
    s_waitcnt lgkmcnt(14)
    v_mfma_f32_32x32x16_bf16 v[32:47], v[216:219], v[148:151], v[32:47]
    ds_read_b64_tr_b16 v[216:217], v238 offset:640
    ds_read_b64_tr_b16 v[218:219], v238 offset:4992
    buffer_load_dwordx4 v236, s[24:27], s59 offen offset:256 nt lds
    s_add_u32 s59, s59, 8192
    s_and_b32 s59, s59, 0x1ffff
    s_waitcnt lgkmcnt(14)
    v_mfma_f32_32x32x16_bf16 v[48:63], v[220:223], v[148:151], v[48:63]
    ds_read_b64_tr_b16 v[220:221], v238 offset:704
    ds_read_b64_tr_b16 v[222:223], v238 offset:5056
    s_waitcnt lgkmcnt(14)
    v_mfma_f32_32x32x16_bf16 v[0:15], v[192:195], v[152:155], v[0:15]
    s_waitcnt lgkmcnt(12)
    v_mfma_f32_32x32x16_bf16 v[16:31], v[196:199], v[152:155], v[16:31]
    s_waitcnt lgkmcnt(10)
    v_mfma_f32_32x32x16_bf16 v[32:47], v[200:203], v[152:155], v[32:47]
    s_waitcnt lgkmcnt(8)
    v_mfma_f32_32x32x16_bf16 v[48:63], v[204:207], v[152:155], v[48:63]
    s_waitcnt lgkmcnt(6)
    v_mfma_f32_32x32x16_bf16 v[0:15], v[208:211], v[156:159], v[0:15]
    s_waitcnt lgkmcnt(4)
    v_mfma_f32_32x32x16_bf16 v[16:31], v[212:215], v[156:159], v[16:31]
    s_waitcnt lgkmcnt(2)
    v_mfma_f32_32x32x16_bf16 v[32:47], v[216:219], v[156:159], v[32:47]
    s_waitcnt lgkmcnt(0)
    v_mfma_f32_32x32x16_bf16 v[48:63], v[220:223], v[156:159], v[48:63]
    s_waitcnt vmcnt(8)
    s_barrier
    s_add_u32 m0, s44, 33792
    ds_read_b64_tr_b16 v[192:193], v238 offset:30720
    ds_read_b64_tr_b16 v[194:195], v238 offset:35072
    ds_read_b64_tr_b16 v[196:197], v238 offset:30784
    ds_read_b64_tr_b16 v[198:199], v238 offset:35136
    buffer_load_dwordx4 v240, s[32:35], s57 offen lds
    s_add_u32 m0, s44, 34880
    ds_read_b64_tr_b16 v[200:201], v238 offset:30848
    ds_read_b64_tr_b16 v[202:203], v238 offset:35200
    ds_read_b64_tr_b16 v[204:205], v238 offset:30912
    ds_read_b64_tr_b16 v[206:207], v238 offset:35264
    buffer_load_dwordx4 v241, s[32:35], s57 offen lds
    s_add_u32 s57, s57, 262144
    s_add_u32 m0, s44, 115712
    ds_read_b64_tr_b16 v[208:209], v238 offset:31232
    ds_read_b64_tr_b16 v[210:211], v238 offset:35584
    ds_read_b64_tr_b16 v[212:213], v238 offset:31296
    ds_read_b64_tr_b16 v[214:215], v238 offset:35648
    buffer_load_dwordx4 v240, s[32:35], s57 offen lds
    s_add_u32 m0, s44, 116800
    ds_read_b64_tr_b16 v[216:217], v238 offset:31360
    ds_read_b64_tr_b16 v[218:219], v238 offset:35712
    ds_read_b64_tr_b16 v[220:221], v238 offset:31424
    ds_read_b64_tr_b16 v[222:223], v238 offset:35776
    buffer_load_dwordx4 v241, s[32:35], s57 offen lds
    s_add_u32 s57, s57, 262144
    s_and_b32 s69, s57, 256
    s_cmp_ge_u32 s57, 5242880
    s_cselect_b32 s57, s69, s57
    s_waitcnt lgkmcnt(14)
    v_mfma_f32_32x32x16_bf16 v[0:15], v[192:195], v[160:163], v[0:15]
    ds_read_b64_tr_b16 v[192:193], v238 offset:39424
    ds_read_b64_tr_b16 v[194:195], v238 offset:43776
    s_waitcnt lgkmcnt(14)
    v_mfma_f32_32x32x16_bf16 v[16:31], v[196:199], v[160:163], v[16:31]
    ds_read_b64_tr_b16 v[196:197], v238 offset:39488
    ds_read_b64_tr_b16 v[198:199], v238 offset:43840
    s_waitcnt lgkmcnt(14)
    v_mfma_f32_32x32x16_bf16 v[32:47], v[200:203], v[160:163], v[32:47]
    ds_read_b64_tr_b16 v[200:201], v238 offset:39552
    ds_read_b64_tr_b16 v[202:203], v238 offset:43904
    s_waitcnt lgkmcnt(14)
    v_mfma_f32_32x32x16_bf16 v[48:63], v[204:207], v[160:163], v[48:63]
    ds_read_b64_tr_b16 v[204:205], v238 offset:39616
    ds_read_b64_tr_b16 v[206:207], v238 offset:43968
    s_add_u32 m0, s54, 25344
    s_waitcnt lgkmcnt(14)
    v_mfma_f32_32x32x16_bf16 v[0:15], v[208:211], v[164:167], v[0:15]
    ds_read_b64_tr_b16 v[208:209], v238 offset:39936
    ds_read_b64_tr_b16 v[210:211], v238 offset:44288
    buffer_load_dwordx4 v236, s[24:27], s59 offen nt lds
    s_waitcnt lgkmcnt(14)
    v_mfma_f32_32x32x16_bf16 v[16:31], v[212:215], v[164:167], v[16:31]
    ds_read_b64_tr_b16 v[212:213], v238 offset:40000
    ds_read_b64_tr_b16 v[214:215], v238 offset:44352
    s_add_u32 m0, s54, 26144
    s_waitcnt lgkmcnt(14)
    v_mfma_f32_32x32x16_bf16 v[32:47], v[216:219], v[164:167], v[32:47]
    ds_read_b64_tr_b16 v[216:217], v238 offset:40064
    ds_read_b64_tr_b16 v[218:219], v238 offset:44416
    buffer_load_dwordx4 v236, s[24:27], s59 offen offset:256 nt lds
    s_add_u32 s59, s59, 8192
    s_and_b32 s59, s59, 0x1ffff
    s_waitcnt lgkmcnt(14)
    v_mfma_f32_32x32x16_bf16 v[48:63], v[220:223], v[164:167], v[48:63]
    ds_read_b64_tr_b16 v[220:221], v238 offset:40128
    ds_read_b64_tr_b16 v[222:223], v238 offset:44480
    s_waitcnt lgkmcnt(14)
    v_mfma_f32_32x32x16_bf16 v[0:15], v[192:195], v[168:171], v[0:15]
    s_waitcnt lgkmcnt(12)
    v_mfma_f32_32x32x16_bf16 v[16:31], v[196:199], v[168:171], v[16:31]
    s_waitcnt lgkmcnt(10)
    v_mfma_f32_32x32x16_bf16 v[32:47], v[200:203], v[168:171], v[32:47]
    s_waitcnt lgkmcnt(8)
    v_mfma_f32_32x32x16_bf16 v[48:63], v[204:207], v[168:171], v[48:63]
    s_waitcnt lgkmcnt(6)
    v_mfma_f32_32x32x16_bf16 v[0:15], v[208:211], v[172:175], v[0:15]
    s_waitcnt lgkmcnt(4)
    v_mfma_f32_32x32x16_bf16 v[16:31], v[212:215], v[172:175], v[16:31]
    s_waitcnt lgkmcnt(2)
    v_mfma_f32_32x32x16_bf16 v[32:47], v[216:219], v[172:175], v[32:47]
    s_waitcnt lgkmcnt(0)
    v_mfma_f32_32x32x16_bf16 v[48:63], v[220:223], v[172:175], v[48:63]
    s_waitcnt vmcnt(8)
    s_barrier
    s_add_u32 m0, s44, 146432
    ds_read_b64_tr_b16 v[192:193], v238 offset:13312
    ds_read_b64_tr_b16 v[194:195], v238 offset:17664
    ds_read_b64_tr_b16 v[196:197], v238 offset:13376
    ds_read_b64_tr_b16 v[198:199], v238 offset:17728
    buffer_load_dwordx4 v240, s[32:35], s57 offen lds
    s_add_u32 m0, s44, 147520
    ds_read_b64_tr_b16 v[200:201], v238 offset:13440
    ds_read_b64_tr_b16 v[202:203], v238 offset:17792
    ds_read_b64_tr_b16 v[204:205], v238 offset:13504
    ds_read_b64_tr_b16 v[206:207], v238 offset:17856
    buffer_load_dwordx4 v241, s[32:35], s57 offen lds
    s_add_u32 s57, s57, 262144
    s_add_u32 m0, s44, 155136
    ds_read_b64_tr_b16 v[208:209], v238 offset:13824
    ds_read_b64_tr_b16 v[210:211], v238 offset:18176
    ds_read_b64_tr_b16 v[212:213], v238 offset:13888
    ds_read_b64_tr_b16 v[214:215], v238 offset:18240
    buffer_load_dwordx4 v240, s[32:35], s57 offen lds
    s_add_u32 m0, s44, 156224
    ds_read_b64_tr_b16 v[216:217], v238 offset:13952
    ds_read_b64_tr_b16 v[218:219], v238 offset:18304
    ds_read_b64_tr_b16 v[220:221], v238 offset:14016
    ds_read_b64_tr_b16 v[222:223], v238 offset:18368
    buffer_load_dwordx4 v241, s[32:35], s57 offen lds
    s_add_u32 s57, s57, 262144
    s_and_b32 s69, s57, 256
    s_cmp_ge_u32 s57, 5242880
    s_cselect_b32 s57, s69, s57
    s_waitcnt lgkmcnt(14)
    v_mfma_f32_32x32x16_bf16 v[0:15], v[192:195], v[176:179], v[0:15]
    ds_read_b64_tr_b16 v[192:193], v238 offset:22016
    ds_read_b64_tr_b16 v[194:195], v238 offset:26368
    s_waitcnt lgkmcnt(14)
    v_mfma_f32_32x32x16_bf16 v[16:31], v[196:199], v[176:179], v[16:31]
    ds_read_b64_tr_b16 v[196:197], v238 offset:22080
    ds_read_b64_tr_b16 v[198:199], v238 offset:26432
    s_waitcnt lgkmcnt(14)
    v_mfma_f32_32x32x16_bf16 v[32:47], v[200:203], v[176:179], v[32:47]
    ds_read_b64_tr_b16 v[200:201], v238 offset:22144
    ds_read_b64_tr_b16 v[202:203], v238 offset:26496
    s_waitcnt lgkmcnt(14)
    v_mfma_f32_32x32x16_bf16 v[48:63], v[204:207], v[176:179], v[48:63]
    ds_read_b64_tr_b16 v[204:205], v238 offset:22208
    ds_read_b64_tr_b16 v[206:207], v238 offset:26560
    s_waitcnt lgkmcnt(14)
    v_mfma_f32_32x32x16_bf16 v[0:15], v[208:211], v[180:183], v[0:15]
    ds_read_b64_tr_b16 v[208:209], v238 offset:22528
    ds_read_b64_tr_b16 v[210:211], v238 offset:26880
    s_waitcnt lgkmcnt(14)
    v_mfma_f32_32x32x16_bf16 v[16:31], v[212:215], v[180:183], v[16:31]
    ds_read_b64_tr_b16 v[212:213], v238 offset:22592
    ds_read_b64_tr_b16 v[214:215], v238 offset:26944
    s_waitcnt lgkmcnt(14)
    v_mfma_f32_32x32x16_bf16 v[32:47], v[216:219], v[180:183], v[32:47]
    ds_read_b64_tr_b16 v[216:217], v238 offset:22656
    ds_read_b64_tr_b16 v[218:219], v238 offset:27008
    s_waitcnt lgkmcnt(14)
    v_mfma_f32_32x32x16_bf16 v[48:63], v[220:223], v[180:183], v[48:63]
    ds_read_b64_tr_b16 v[220:221], v238 offset:22720
    ds_read_b64_tr_b16 v[222:223], v238 offset:27072
    s_waitcnt lgkmcnt(14)
    v_mfma_f32_32x32x16_bf16 v[0:15], v[192:195], v[184:187], v[0:15]
    s_waitcnt lgkmcnt(12)
    v_mfma_f32_32x32x16_bf16 v[16:31], v[196:199], v[184:187], v[16:31]
    s_waitcnt lgkmcnt(10)
    v_mfma_f32_32x32x16_bf16 v[32:47], v[200:203], v[184:187], v[32:47]
    s_waitcnt lgkmcnt(8)
    v_mfma_f32_32x32x16_bf16 v[48:63], v[204:207], v[184:187], v[48:63]
    s_waitcnt lgkmcnt(6)
    v_mfma_f32_32x32x16_bf16 v[0:15], v[208:211], v[188:191], v[0:15]
    s_waitcnt lgkmcnt(4)
    v_mfma_f32_32x32x16_bf16 v[16:31], v[212:215], v[188:191], v[16:31]
    s_waitcnt lgkmcnt(2)
    v_mfma_f32_32x32x16_bf16 v[32:47], v[216:219], v[188:191], v[32:47]
    s_waitcnt lgkmcnt(0)
    v_mfma_f32_32x32x16_bf16 v[48:63], v[220:223], v[188:191], v[48:63]
    s_waitcnt vmcnt(6)
    s_barrier
    ds_read_b64_tr_b16 v[192:193], v242 offset:0
    ds_read_b64_tr_b16 v[194:195], v242 offset:4352
    ds_read_b64_tr_b16 v[196:197], v242 offset:64
    ds_read_b64_tr_b16 v[198:199], v242 offset:4416
    ds_read_b64_tr_b16 v[200:201], v242 offset:128
    ds_read_b64_tr_b16 v[202:203], v242 offset:4480
    ds_read_b64_tr_b16 v[204:205], v242 offset:192
    ds_read_b64_tr_b16 v[206:207], v242 offset:4544
    ds_read_b64_tr_b16 v[208:209], v242 offset:512
    ds_read_b64_tr_b16 v[210:211], v242 offset:4864
    ds_read_b64_tr_b16 v[212:213], v242 offset:576
    ds_read_b64_tr_b16 v[214:215], v242 offset:4928
    ds_read_b64_tr_b16 v[216:217], v242 offset:640
    ds_read_b64_tr_b16 v[218:219], v242 offset:4992
    ds_read_b64_tr_b16 v[220:221], v242 offset:704
    ds_read_b64_tr_b16 v[222:223], v242 offset:5056
    s_waitcnt lgkmcnt(14)
    v_mfma_f32_32x32x16_bf16 v[0:15], v[192:195], v[128:131], v[0:15]
    ds_read_b64_tr_b16 v[192:193], v238 offset:0
    ds_read_b64_tr_b16 v[194:195], v238 offset:4352
    s_waitcnt lgkmcnt(14)
    v_mfma_f32_32x32x16_bf16 v[16:31], v[196:199], v[128:131], v[16:31]
    ds_read_b64_tr_b16 v[196:197], v238 offset:64
    ds_read_b64_tr_b16 v[198:199], v238 offset:4416
    s_waitcnt lgkmcnt(14)
    v_mfma_f32_32x32x16_bf16 v[32:47], v[200:203], v[128:131], v[32:47]
    ds_read_b64_tr_b16 v[200:201], v238 offset:128
    ds_read_b64_tr_b16 v[202:203], v238 offset:4480
    s_waitcnt lgkmcnt(14)
    v_mfma_f32_32x32x16_bf16 v[48:63], v[204:207], v[128:131], v[48:63]
    ds_read_b64_tr_b16 v[204:205], v238 offset:192
    ds_read_b64_tr_b16 v[206:207], v238 offset:4544
    s_add_u32 m0, s55, 0
    s_waitcnt lgkmcnt(14)
    v_mfma_f32_32x32x16_bf16 v[0:15], v[208:211], v[132:135], v[0:15]
    ds_read_b64_tr_b16 v[208:209], v238 offset:512
    ds_read_b64_tr_b16 v[210:211], v238 offset:4864
    buffer_load_dwordx4 v237, s[28:31], s60 offen nt lds
    s_waitcnt lgkmcnt(14)
    v_mfma_f32_32x32x16_bf16 v[16:31], v[212:215], v[132:135], v[16:31]
    ds_read_b64_tr_b16 v[212:213], v238 offset:576
    ds_read_b64_tr_b16 v[214:215], v238 offset:4928
    s_add_u32 m0, s55, 832
    s_waitcnt lgkmcnt(14)
    v_mfma_f32_32x32x16_bf16 v[32:47], v[216:219], v[132:135], v[32:47]
    ds_read_b64_tr_b16 v[216:217], v238 offset:640
    ds_read_b64_tr_b16 v[218:219], v238 offset:4992
    buffer_load_dwordx4 v237, s[28:31], s60 offen offset:256 nt lds
    s_add_u32 s60, s60, 8192
    s_and_b32 s60, s60, 0x1ffff
    s_waitcnt lgkmcnt(14)
    v_mfma_f32_32x32x16_bf16 v[48:63], v[220:223], v[132:135], v[48:63]
    ds_read_b64_tr_b16 v[220:221], v238 offset:704
    ds_read_b64_tr_b16 v[222:223], v238 offset:5056
    s_waitcnt lgkmcnt(14)
    v_mfma_f32_32x32x16_bf16 v[0:15], v[192:195], v[136:139], v[0:15]
    s_waitcnt lgkmcnt(12)
    v_mfma_f32_32x32x16_bf16 v[16:31], v[196:199], v[136:139], v[16:31]
    s_waitcnt lgkmcnt(10)
    v_mfma_f32_32x32x16_bf16 v[32:47], v[200:203], v[136:139], v[32:47]
    s_waitcnt lgkmcnt(8)
    v_mfma_f32_32x32x16_bf16 v[48:63], v[204:207], v[136:139], v[48:63]
    s_waitcnt lgkmcnt(6)
    v_mfma_f32_32x32x16_bf16 v[0:15], v[208:211], v[140:143], v[0:15]
    s_waitcnt lgkmcnt(4)
    v_mfma_f32_32x32x16_bf16 v[16:31], v[212:215], v[140:143], v[16:31]
    s_waitcnt lgkmcnt(2)
    v_mfma_f32_32x32x16_bf16 v[32:47], v[216:219], v[140:143], v[32:47]
    s_waitcnt lgkmcnt(0)
    v_mfma_f32_32x32x16_bf16 v[48:63], v[220:223], v[140:143], v[48:63]
    s_waitcnt vmcnt(2)
    s_barrier
    ds_read_b64_tr_b16 v[192:193], v238 offset:30720
    ds_read_b64_tr_b16 v[194:195], v238 offset:35072
    ds_read_b64_tr_b16 v[196:197], v238 offset:30784
    ds_read_b64_tr_b16 v[198:199], v238 offset:35136
    ds_read_b64_tr_b16 v[200:201], v238 offset:30848
    ds_read_b64_tr_b16 v[202:203], v238 offset:35200
    ds_read_b64_tr_b16 v[204:205], v238 offset:30912
    ds_read_b64_tr_b16 v[206:207], v238 offset:35264
    ds_read_b64_tr_b16 v[208:209], v238 offset:31232
    ds_read_b64_tr_b16 v[210:211], v238 offset:35584
    ds_read_b64_tr_b16 v[212:213], v238 offset:31296
    ds_read_b64_tr_b16 v[214:215], v238 offset:35648
    ds_read_b64_tr_b16 v[216:217], v238 offset:31360
    ds_read_b64_tr_b16 v[218:219], v238 offset:35712
    ds_read_b64_tr_b16 v[220:221], v238 offset:31424
    ds_read_b64_tr_b16 v[222:223], v238 offset:35776
    s_waitcnt lgkmcnt(14)
    v_mfma_f32_32x32x16_bf16 v[0:15], v[192:195], v[112:115], v[0:15]
    ds_read_b64_tr_b16 v[192:193], v238 offset:39424
    ds_read_b64_tr_b16 v[194:195], v238 offset:43776
    s_waitcnt lgkmcnt(14)
    v_mfma_f32_32x32x16_bf16 v[16:31], v[196:199], v[112:115], v[16:31]
    ds_read_b64_tr_b16 v[196:197], v238 offset:39488
    ds_read_b64_tr_b16 v[198:199], v238 offset:43840
    s_waitcnt lgkmcnt(14)
    v_mfma_f32_32x32x16_bf16 v[32:47], v[200:203], v[112:115], v[32:47]
    ds_read_b64_tr_b16 v[200:201], v238 offset:39552
    ds_read_b64_tr_b16 v[202:203], v238 offset:43904
    s_waitcnt lgkmcnt(14)
    v_mfma_f32_32x32x16_bf16 v[48:63], v[204:207], v[112:115], v[48:63]
    ds_read_b64_tr_b16 v[204:205], v238 offset:39616
    ds_read_b64_tr_b16 v[206:207], v238 offset:43968
    s_add_u32 m0, s55, 8704
    s_waitcnt lgkmcnt(14)
    v_mfma_f32_32x32x16_bf16 v[0:15], v[208:211], v[116:119], v[0:15]
    ds_read_b64_tr_b16 v[208:209], v238 offset:39936
    ds_read_b64_tr_b16 v[210:211], v238 offset:44288
    buffer_load_dwordx4 v237, s[28:31], s60 offen nt lds
    s_waitcnt lgkmcnt(14)
    v_mfma_f32_32x32x16_bf16 v[16:31], v[212:215], v[116:119], v[16:31]
    ds_read_b64_tr_b16 v[212:213], v238 offset:40000
    ds_read_b64_tr_b16 v[214:215], v238 offset:44352
    s_add_u32 m0, s55, 9536
    s_waitcnt lgkmcnt(14)
    v_mfma_f32_32x32x16_bf16 v[32:47], v[216:219], v[116:119], v[32:47]
    ds_read_b64_tr_b16 v[216:217], v238 offset:40064
    ds_read_b64_tr_b16 v[218:219], v238 offset:44416
    buffer_load_dwordx4 v237, s[28:31], s60 offen offset:256 nt lds
    s_add_u32 s60, s60, 8192
    s_and_b32 s60, s60, 0x1ffff
    s_waitcnt lgkmcnt(14)
    v_mfma_f32_32x32x16_bf16 v[48:63], v[220:223], v[116:119], v[48:63]
    ds_read_b64_tr_b16 v[220:221], v238 offset:40128
    ds_read_b64_tr_b16 v[222:223], v238 offset:44480
    s_waitcnt lgkmcnt(14)
    v_mfma_f32_32x32x16_bf16 v[0:15], v[192:195], v[120:123], v[0:15]
    ds_read_b128 v[160:163], v234 offset:0
    ds_read_b128 v[164:167], v234 offset:32
    s_waitcnt lgkmcnt(14)
    v_mfma_f32_32x32x16_bf16 v[16:31], v[196:199], v[120:123], v[16:31]
    ds_read_b128 v[168:171], v234 offset:64
    ds_read_b128 v[172:175], v234 offset:96
    s_waitcnt lgkmcnt(14)
    v_mfma_f32_32x32x16_bf16 v[32:47], v[200:203], v[120:123], v[32:47]
    ds_read_b128 v[176:179], v234 offset:128
    ds_read_b128 v[180:183], v234 offset:160
    s_waitcnt lgkmcnt(14)
    v_mfma_f32_32x32x16_bf16 v[48:63], v[204:207], v[120:123], v[48:63]
    ds_read_b128 v[184:187], v234 offset:192
    ds_read_b128 v[188:191], v234 offset:224
    s_waitcnt lgkmcnt(14)
    v_mfma_f32_32x32x16_bf16 v[0:15], v[208:211], v[124:127], v[0:15]
    ds_read_b128 v[96:99], v234 offset:8448
    ds_read_b128 v[100:103], v234 offset:8480
    s_waitcnt lgkmcnt(14)
    v_mfma_f32_32x32x16_bf16 v[16:31], v[212:215], v[124:127], v[16:31]
    ds_read_b128 v[104:107], v234 offset:8512
    ds_read_b128 v[108:111], v234 offset:8544
    s_waitcnt lgkmcnt(14)
    v_mfma_f32_32x32x16_bf16 v[32:47], v[216:219], v[124:127], v[32:47]
    ds_read_b128 v[144:147], v234 offset:8576
    ds_read_b128 v[148:151], v234 offset:8608
    s_waitcnt lgkmcnt(14)
    v_mfma_f32_32x32x16_bf16 v[48:63], v[220:223], v[124:127], v[48:63]
    ds_read_b128 v[152:155], v234 offset:8640
    ds_read_b128 v[156:159], v234 offset:8672
L_shared:
    s_waitcnt lgkmcnt(0)
    s_barrier
    s_nop 7
    v_mul_f32 v0, s64, v0
    v_mul_f32 v1, s64, v1
    v_mul_f32 v2, s64, v2
    v_mul_f32 v3, s64, v3
    v_mul_f32 v4, s64, v4
    v_mul_f32 v5, s64, v5
    v_mul_f32 v6, s64, v6
    v_mul_f32 v7, s64, v7
    v_cvt_pk_bf16_f32 v64, v0, v1
    v_cvt_pk_bf16_f32 v65, v2, v3
    v_cvt_pk_bf16_f32 v66, v4, v5
    v_cvt_pk_bf16_f32 v67, v6, v7
    v_mul_f32 v8, s64, v8
    v_mul_f32 v9, s64, v9
    v_mul_f32 v10, s64, v10
    v_mul_f32 v11, s64, v11
    v_mul_f32 v12, s64, v12
    v_mul_f32 v13, s64, v13
    v_mul_f32 v14, s64, v14
    v_mul_f32 v15, s64, v15
    v_cvt_pk_bf16_f32 v68, v8, v9
    v_cvt_pk_bf16_f32 v69, v10, v11
    v_cvt_pk_bf16_f32 v70, v12, v13
    v_cvt_pk_bf16_f32 v71, v14, v15
    v_mfma_f32_32x32x16_bf16 v[112:127], v[160:163], v[64:67], 0
    v_mul_f32 v16, s64, v16
    v_mul_f32 v17, s64, v17
    v_mul_f32 v18, s64, v18
    v_mul_f32 v19, s64, v19
    v_mul_f32 v20, s64, v20
    v_mul_f32 v21, s64, v21
    v_mul_f32 v22, s64, v22
    v_mul_f32 v23, s64, v23
    v_cvt_pk_bf16_f32 v72, v16, v17
    v_cvt_pk_bf16_f32 v73, v18, v19
    v_cvt_pk_bf16_f32 v74, v20, v21
    v_cvt_pk_bf16_f32 v75, v22, v23
    s_add_u32 m0, s54, 0
    v_mfma_f32_32x32x16_bf16 v[112:127], v[164:167], v[68:71], v[112:127]
    v_mul_f32 v24, s64, v24
    v_mul_f32 v25, s64, v25
    v_mul_f32 v26, s64, v26
    v_mul_f32 v27, s64, v27
    v_mul_f32 v28, s64, v28
    v_mul_f32 v29, s64, v29
    v_mul_f32 v30, s64, v30
    v_mul_f32 v31, s64, v31
    v_cvt_pk_bf16_f32 v76, v24, v25
    v_cvt_pk_bf16_f32 v77, v26, v27
    v_cvt_pk_bf16_f32 v78, v28, v29
    v_cvt_pk_bf16_f32 v79, v30, v31
    buffer_load_dwordx4 v236, s[24:27], s59 offen nt lds
    v_mfma_f32_32x32x16_bf16 v[112:127], v[168:171], v[72:75], v[112:127]
    v_mul_f32 v32, s64, v32
    v_mul_f32 v33, s64, v33
    v_mul_f32 v34, s64, v34
    v_mul_f32 v35, s64, v35
    v_mul_f32 v36, s64, v36
    v_mul_f32 v37, s64, v37
    v_mul_f32 v38, s64, v38
    v_mul_f32 v39, s64, v39
    v_cvt_pk_bf16_f32 v80, v32, v33
    v_cvt_pk_bf16_f32 v81, v34, v35
    v_cvt_pk_bf16_f32 v82, v36, v37
    v_cvt_pk_bf16_f32 v83, v38, v39
    s_add_u32 m0, s54, 800
    v_mfma_f32_32x32x16_bf16 v[112:127], v[172:175], v[76:79], v[112:127]
    v_mul_f32 v40, s64, v40
    v_mul_f32 v41, s64, v41
    v_mul_f32 v42, s64, v42
    v_mul_f32 v43, s64, v43
    v_mul_f32 v44, s64, v44
    v_mul_f32 v45, s64, v45
    v_mul_f32 v46, s64, v46
    v_mul_f32 v47, s64, v47
    v_cvt_pk_bf16_f32 v84, v40, v41
    v_cvt_pk_bf16_f32 v85, v42, v43
    v_cvt_pk_bf16_f32 v86, v44, v45
    v_cvt_pk_bf16_f32 v87, v46, v47
    buffer_load_dwordx4 v236, s[24:27], s59 offen offset:256 nt lds
    v_mfma_f32_32x32x16_bf16 v[112:127], v[176:179], v[80:83], v[112:127]
    v_mul_f32 v48, s64, v48
    v_mul_f32 v49, s64, v49
    v_mul_f32 v50, s64, v50
    v_mul_f32 v51, s64, v51
    v_mul_f32 v52, s64, v52
    v_mul_f32 v53, s64, v53
    v_mul_f32 v54, s64, v54
    v_mul_f32 v55, s64, v55
    v_cvt_pk_bf16_f32 v88, v48, v49
    v_cvt_pk_bf16_f32 v89, v50, v51
    v_cvt_pk_bf16_f32 v90, v52, v53
    v_cvt_pk_bf16_f32 v91, v54, v55
    v_mfma_f32_32x32x16_bf16 v[112:127], v[180:183], v[84:87], v[112:127]
    v_mul_f32 v56, s64, v56
    v_mul_f32 v57, s64, v57
    v_mul_f32 v58, s64, v58
    v_mul_f32 v59, s64, v59
    v_mul_f32 v60, s64, v60
    v_mul_f32 v61, s64, v61
    v_mul_f32 v62, s64, v62
    v_mul_f32 v63, s64, v63
    v_cvt_pk_bf16_f32 v92, v56, v57
    v_cvt_pk_bf16_f32 v93, v58, v59
    v_cvt_pk_bf16_f32 v94, v60, v61
    v_cvt_pk_bf16_f32 v95, v62, v63
    v_mfma_f32_32x32x16_bf16 v[112:127], v[184:187], v[88:91], v[112:127]
    ds_read_b128 v[160:163], v234 offset:16896
    ds_read_b128 v[164:167], v234 offset:16928
    ds_read_b128 v[168:171], v234 offset:16960
    ds_read_b128 v[172:175], v234 offset:16992
    s_add_u32 m0, s55, 17408
    v_mfma_f32_32x32x16_bf16 v[112:127], v[188:191], v[92:95], v[112:127]
    ds_read_b128 v[176:179], v234 offset:17024
    ds_read_b128 v[180:183], v234 offset:17056
    ds_read_b128 v[184:187], v234 offset:17088
    ds_read_b128 v[188:191], v234 offset:17120
    s_add_u32 s59, s59, 8192
    s_and_b32 s59, s59, 0x1ffff
    buffer_load_dwordx4 v237, s[28:31], s60 offen nt lds
    s_add_u32 m0, s55, 18240
    s_nop 0
    buffer_load_dwordx4 v237, s[28:31], s60 offen offset:256 nt lds
    s_nop 1
    v_max3_f32 v244, v112, v113, v114
    v_max3_f32 v244, v244, v115, v116
    v_max3_f32 v244, v244, v117, v118
    v_max3_f32 v244, v244, v119, v120
    v_max3_f32 v244, v244, v121, v122
    v_max3_f32 v244, v244, v123, v124
    v_max3_f32 v244, v244, v125, v126
    v_max_f32 v244, v244, v127
    v_mov_b32 v245, v244
    s_nop 1
    v_permlane32_swap_b32 v244, v245
    v_max_f32 v244, v244, v245
    v_sub_f32 v128, 0, v244
    v_sub_f32 v129, 0, v244
    v_sub_f32 v130, 0, v244
    v_sub_f32 v131, 0, v244
    v_sub_f32 v132, 0, v244
    v_sub_f32 v133, 0, v244
    v_sub_f32 v134, 0, v244
    v_sub_f32 v135, 0, v244
    v_sub_f32 v136, 0, v244
    v_sub_f32 v137, 0, v244
    v_sub_f32 v138, 0, v244
    v_sub_f32 v139, 0, v244
    v_sub_f32 v140, 0, v244
    v_sub_f32 v141, 0, v244
    v_sub_f32 v142, 0, v244
    v_sub_f32 v143, 0, v244
    v_sub_f32 v112, v112, v244
    v_sub_f32 v113, v113, v244
    s_add_u32 m0, s54, 8448
    v_mfma_f32_32x32x16_bf16 v[128:143], v[96:99], v[64:67], v[128:143]
    v_sub_f32 v114, v114, v244
    v_exp_f32 v192, v112
    v_sub_f32 v115, v115, v244
    v_exp_f32 v193, v113
    v_sub_f32 v116, v116, v244
    v_exp_f32 v194, v114
    v_add_f32 v232, v192, v193
    v_sub_f32 v117, v117, v244
    s_add_u32 s60, s60, 8192
    s_and_b32 s60, s60, 0x1ffff
    buffer_load_dwordx4 v236, s[24:27], s59 offen nt lds
    v_mfma_f32_32x32x16_bf16 v[128:143], v[100:103], v[68:71], v[128:143]
    v_exp_f32 v195, v115
    v_add_f32 v232, v232, v194
    v_sub_f32 v118, v118, v244
    v_exp_f32 v196, v116
    v_add_f32 v232, v232, v195
    v_sub_f32 v119, v119, v244
    v_exp_f32 v197, v117
    s_add_u32 m0, s54, 9248
    v_mfma_f32_32x32x16_bf16 v[128:143], v[104:107], v[72:75], v[128:143]
    v_add_f32 v232, v232, v196
    v_sub_f32 v120, v120, v244
    v_exp_f32 v198, v118
    v_add_f32 v232, v232, v197
    v_sub_f32 v121, v121, v244
    v_exp_f32 v199, v119
    v_add_f32 v232, v232, v198
    buffer_load_dwordx4 v236, s[24:27], s59 offen offset:256 nt lds
    s_add_u32 s59, s59, 8192
    s_and_b32 s59, s59, 0x1ffff
    v_mfma_f32_32x32x16_bf16 v[128:143], v[108:111], v[76:79], v[128:143]
    v_sub_f32 v122, v122, v244
    v_exp_f32 v200, v120
    v_add_f32 v232, v232, v199
    v_sub_f32 v123, v123, v244
    v_exp_f32 v201, v121
    v_add_f32 v232, v232, v200
    v_sub_f32 v124, v124, v244
    v_exp_f32 v202, v122
    v_mfma_f32_32x32x16_bf16 v[128:143], v[144:147], v[80:83], v[128:143]
    v_add_f32 v232, v232, v201
    v_sub_f32 v125, v125, v244
    v_exp_f32 v203, v123
    v_add_f32 v232, v232, v202
    v_sub_f32 v126, v126, v244
    v_exp_f32 v204, v124
    v_add_f32 v232, v232, v203
    v_mfma_f32_32x32x16_bf16 v[128:143], v[148:151], v[84:87], v[128:143]
    v_sub_f32 v127, v127, v244
    v_exp_f32 v205, v125
    v_add_f32 v232, v232, v204
    v_exp_f32 v206, v126
    v_add_f32 v232, v232, v205
    v_exp_f32 v207, v127
    v_add_f32 v232, v232, v206
    v_mfma_f32_32x32x16_bf16 v[128:143], v[152:155], v[88:91], v[128:143]
    v_sub_f32 v96, 0, v244
    v_add_f32 v232, v232, v207
    v_sub_f32 v97, 0, v244
    v_sub_f32 v98, 0, v244
    v_sub_f32 v99, 0, v244
    v_sub_f32 v100, 0, v244
    v_sub_f32 v101, 0, v244
    v_sub_f32 v102, 0, v244
    v_sub_f32 v103, 0, v244
    v_sub_f32 v104, 0, v244
    v_sub_f32 v105, 0, v244
    v_sub_f32 v106, 0, v244
    v_sub_f32 v107, 0, v244
    v_mfma_f32_32x32x16_bf16 v[128:143], v[156:159], v[92:95], v[128:143]
    v_sub_f32 v108, 0, v244
    v_sub_f32 v109, 0, v244
    v_sub_f32 v110, 0, v244
    v_sub_f32 v111, 0, v244
    v_cvt_pk_bf16_f32 v144, v192, v193
    v_cvt_pk_bf16_f32 v145, v194, v195
    v_cvt_pk_bf16_f32 v146, v196, v197
    v_cvt_pk_bf16_f32 v147, v198, v199
    v_cvt_pk_bf16_f32 v148, v200, v201
    v_cvt_pk_bf16_f32 v149, v202, v203
    v_cvt_pk_bf16_f32 v150, v204, v205
    v_cvt_pk_bf16_f32 v151, v206, v207
    s_lshl_b32 s69, s49, 2
    s_add_u32 s69, s69, s99
    s_lshl_b32 s69, s69, 2
    s_add_u32 s69, s69, s96
    s_mul_i32 s69, s69, 36864
    s_add_u32 s69, s69, 16777216
    s_mul_i32 s51, s98, 9216
    s_add_u32 s69, s69, s51
    s_waitcnt vmcnt(8) lgkmcnt(0)
    s_barrier
    v_mfma_f32_32x32x16_bf16 v[112:127], v[160:163], v[64:67], v[96:111]
    ds_read_b64_tr_b16 v[192:193], v235 offset:0
    ds_read_b64_tr_b16 v[194:195], v235 offset:256
    v_exp_f32 v224, v128
    s_add_u32 m0, s54, 16896
    v_mfma_f32_32x32x16_bf16 v[112:127], v[164:167], v[68:71], v[112:127]
    ds_read_b64_tr_b16 v[196:197], v235 offset:64
    ds_read_b64_tr_b16 v[198:199], v235 offset:320
    buffer_load_dwordx4 v236, s[24:27], s59 offen nt lds
    v_exp_f32 v225, v129
    v_mfma_f32_32x32x16_bf16 v[112:127], v[168:171], v[72:75], v[112:127]
    ds_read_b64_tr_b16 v[200:201], v235 offset:128
    ds_read_b64_tr_b16 v[202:203], v235 offset:384
    v_add_f32 v233, v224, v225
    v_cvt_pk_bf16_f32 v152, v224, v225
    v_exp_f32 v226, v130
    v_mfma_f32_32x32x16_bf16 v[112:127], v[172:175], v[76:79], v[112:127]
    ds_read_b64_tr_b16 v[204:205], v235 offset:192
    ds_read_b64_tr_b16 v[206:207], v235 offset:448
    v_add_f32 v233, v233, v226
    v_exp_f32 v227, v131
    v_mfma_f32_32x32x16_bf16 v[112:127], v[176:179], v[80:83], v[112:127]
    ds_read_b64_tr_b16 v[208:209], v235 offset:512
    ds_read_b64_tr_b16 v[210:211], v235 offset:768
    ds_read_b128 v[160:163], v234 offset:25344
    v_add_f32 v233, v233, v227
    v_cvt_pk_bf16_f32 v153, v226, v227
    v_exp_f32 v228, v132
    s_add_u32 m0, s54, 17696
    v_mfma_f32_32x32x16_bf16 v[112:127], v[180:183], v[84:87], v[112:127]
    ds_read_b64_tr_b16 v[212:213], v235 offset:576
    ds_read_b64_tr_b16 v[214:215], v235 offset:832
    ds_read_b128 v[164:167], v234 offset:25376
    buffer_load_dwordx4 v236, s[24:27], s59 offen offset:256 nt lds
    v_add_f32 v233, v233, v228
    v_exp_f32 v229, v133
    v_mfma_f32_32x32x16_bf16 v[112:127], v[184:187], v[88:91], v[112:127]
    ds_read_b64_tr_b16 v[216:217], v235 offset:640
    ds_read_b64_tr_b16 v[218:219], v235 offset:896
    ds_read_b128 v[168:171], v234 offset:25408
    v_add_f32 v233, v233, v229
    v_cvt_pk_bf16_f32 v154, v228, v229
    v_exp_f32 v230, v134
    v_mfma_f32_32x32x16_bf16 v[112:127], v[188:191], v[92:95], v[112:127]
    ds_read_b64_tr_b16 v[220:221], v235 offset:704
    ds_read_b64_tr_b16 v[222:223], v235 offset:960
    ds_read_b128 v[172:175], v234 offset:25440
    v_add_f32 v233, v233, v230
    v_exp_f32 v231, v135
    s_waitcnt lgkmcnt(15)
    v_mfma_f32_32x32x16_bf16 v[0:15], v[192:195], v[144:147], 0
    ds_read_b128 v[176:179], v234 offset:25472
    v_add_f32 v233, v233, v231
    v_cvt_pk_bf16_f32 v155, v230, v231
    v_exp_f32 v224, v136
    s_add_u32 m0, s55, 26112
    v_mfma_f32_32x32x16_bf16 v[16:31], v[196:199], v[144:147], 0
    ds_read_b128 v[180:183], v234 offset:25504
    s_add_u32 s59, s59, 8192
    s_and_b32 s59, s59, 0x1ffff
    buffer_load_dwordx4 v237, s[28:31], s60 offen nt lds
    v_add_f32 v233, v233, v224
    v_exp_f32 v225, v137
    s_waitcnt lgkmcnt(15)
    v_mfma_f32_32x32x16_bf16 v[32:47], v[200:203], v[144:147], 0
    ds_read_b128 v[184:187], v234 offset:25536
    v_add_f32 v233, v233, v225
    v_cvt_pk_bf16_f32 v156, v224, v225
    v_exp_f32 v226, v138
    s_waitcnt lgkmcnt(15)
    v_mfma_f32_32x32x16_bf16 v[48:63], v[204:207], v[144:147], 0
    ds_read_b128 v[188:191], v234 offset:25568
    v_add_f32 v233, v233, v226
    v_exp_f32 v227, v139
    s_waitcnt lgkmcnt(14)
    v_mfma_f32_32x32x16_bf16 v[0:15], v[208:211], v[148:151], v[0:15]
    v_add_f32 v233, v233, v227
    v_cvt_pk_bf16_f32 v157, v226, v227
    v_exp_f32 v228, v140
    s_add_u32 m0, s55, 26944
    s_waitcnt lgkmcnt(11)
    v_mfma_f32_32x32x16_bf16 v[16:31], v[212:215], v[148:151], v[16:31]
    buffer_load_dwordx4 v237, s[28:31], s60 offen offset:256 nt lds
    s_add_u32 s60, s60, 8192
    s_and_b32 s60, s60, 0x1ffff
    v_add_f32 v233, v233, v228
    v_exp_f32 v229, v141
    s_waitcnt lgkmcnt(8)
    v_mfma_f32_32x32x16_bf16 v[32:47], v[216:219], v[148:151], v[32:47]
    v_add_f32 v233, v233, v229
    v_cvt_pk_bf16_f32 v158, v228, v229
    v_exp_f32 v230, v142
    s_waitcnt lgkmcnt(5)
    v_mfma_f32_32x32x16_bf16 v[48:63], v[220:223], v[148:151], v[48:63]
    v_add_f32 v233, v233, v230
    v_exp_f32 v231, v143
    s_nop 0
    v_add_f32 v233, v233, v231
    v_cvt_pk_bf16_f32 v159, v230, v231
    v_cmp_ngt_f32 vcc, s63, v233
    s_cbranch_vccnz L_fb0
L_ret0:
    v_add_f32 v232, v232, v233
    s_mov_b32 s61, 2
L_f_at_loop1:
    s_waitcnt vmcnt(8) lgkmcnt(0)
    s_barrier
    v_mfma_f32_32x32x16_bf16 v[128:143], v[160:163], v[64:67], v[96:111]
    ds_read_b64_tr_b16 v[192:193], v235 offset:8704
    ds_read_b64_tr_b16 v[194:195], v235 offset:8960
    v_exp_f32 v224, v112
    s_add_u32 m0, s54, 25344
    v_mfma_f32_32x32x16_bf16 v[128:143], v[164:167], v[68:71], v[128:143]
    ds_read_b64_tr_b16 v[196:197], v235 offset:8768
    ds_read_b64_tr_b16 v[198:199], v235 offset:9024
    buffer_load_dwordx4 v236, s[24:27], s59 offen nt lds
    v_exp_f32 v225, v113
    v_mfma_f32_32x32x16_bf16 v[128:143], v[168:171], v[72:75], v[128:143]
    ds_read_b64_tr_b16 v[200:201], v235 offset:8832
    ds_read_b64_tr_b16 v[202:203], v235 offset:9088
    v_add_f32 v233, v224, v225
    v_cvt_pk_bf16_f32 v144, v224, v225
    v_exp_f32 v226, v114
    v_mfma_f32_32x32x16_bf16 v[128:143], v[172:175], v[76:79], v[128:143]
    ds_read_b64_tr_b16 v[204:205], v235 offset:8896
    ds_read_b64_tr_b16 v[206:207], v235 offset:9152
    v_add_f32 v233, v233, v226
    v_exp_f32 v227, v115
    v_mfma_f32_32x32x16_bf16 v[128:143], v[176:179], v[80:83], v[128:143]
    ds_read_b64_tr_b16 v[208:209], v235 offset:9216
    ds_read_b64_tr_b16 v[210:211], v235 offset:9472
    ds_read_b128 v[160:163], v234 offset:0
    v_add_f32 v233, v233, v227
    v_cvt_pk_bf16_f32 v145, v226, v227
    v_exp_f32 v228, v116
    s_add_u32 m0, s54, 26144
    v_mfma_f32_32x32x16_bf16 v[128:143], v[180:183], v[84:87], v[128:143]
    ds_read_b64_tr_b16 v[212:213], v235 offset:9280
    ds_read_b64_tr_b16 v[214:215], v235 offset:9536
    ds_read_b128 v[164:167], v234 offset:32
    buffer_load_dwordx4 v236, s[24:27], s59 offen offset:256 nt lds
    v_add_f32 v233, v233, v228
    v_exp_f32 v229, v117
    v_mfma_f32_32x32x16_bf16 v[128:143], v[184:187], v[88:91], v[128:143]
    ds_read_b64_tr_b16 v[216:217], v235 offset:9344
    ds_read_b64_tr_b16 v[218:219], v235 offset:9600
    ds_read_b128 v[168:171], v234 offset:64
    v_add_f32 v233, v233, v229
    v_cvt_pk_bf16_f32 v146, v228, v229
    v_exp_f32 v230, v118
    v_mfma_f32_32x32x16_bf16 v[128:143], v[188:191], v[92:95], v[128:143]
    ds_read_b64_tr_b16 v[220:221], v235 offset:9408
    ds_read_b64_tr_b16 v[222:223], v235 offset:9664
    ds_read_b128 v[172:175], v234 offset:96
    v_add_f32 v233, v233, v230
    v_exp_f32 v231, v119
    s_waitcnt lgkmcnt(15)
    v_mfma_f32_32x32x16_bf16 v[0:15], v[192:195], v[152:155], v[0:15]
    ds_read_b128 v[176:179], v234 offset:128
    v_add_f32 v233, v233, v231
    v_cvt_pk_bf16_f32 v147, v230, v231
    v_exp_f32 v224, v120
    s_add_u32 m0, s55, 0
    v_mfma_f32_32x32x16_bf16 v[16:31], v[196:199], v[152:155], v[16:31]
    ds_read_b128 v[180:183], v234 offset:160
    s_add_u32 s59, s59, 8192
    s_and_b32 s59, s59, 0x1ffff
    buffer_load_dwordx4 v237, s[28:31], s60 offen nt lds
    v_add_f32 v233, v233, v224
    v_exp_f32 v225, v121
    s_waitcnt lgkmcnt(15)
    v_mfma_f32_32x32x16_bf16 v[32:47], v[200:203], v[152:155], v[32:47]
    ds_read_b128 v[184:187], v234 offset:192
    v_add_f32 v233, v233, v225
    v_cvt_pk_bf16_f32 v148, v224, v225
    v_exp_f32 v226, v122
    s_waitcnt lgkmcnt(15)
    v_mfma_f32_32x32x16_bf16 v[48:63], v[204:207], v[152:155], v[48:63]
    ds_read_b128 v[188:191], v234 offset:224
    v_add_f32 v233, v233, v226
    v_exp_f32 v227, v123
    s_waitcnt lgkmcnt(14)
    v_mfma_f32_32x32x16_bf16 v[0:15], v[208:211], v[156:159], v[0:15]
    v_add_f32 v233, v233, v227
    v_cvt_pk_bf16_f32 v149, v226, v227
    v_exp_f32 v228, v124
    s_add_u32 m0, s55, 832
    s_waitcnt lgkmcnt(11)
    v_mfma_f32_32x32x16_bf16 v[16:31], v[212:215], v[156:159], v[16:31]
    buffer_load_dwordx4 v237, s[28:31], s60 offen offset:256 nt lds
    s_add_u32 s60, s60, 8192
    s_and_b32 s60, s60, 0x1ffff
    v_add_f32 v233, v233, v228
    v_exp_f32 v229, v125
    s_waitcnt lgkmcnt(8)
    v_mfma_f32_32x32x16_bf16 v[32:47], v[216:219], v[156:159], v[32:47]
    v_add_f32 v233, v233, v229
    v_cvt_pk_bf16_f32 v150, v228, v229
    v_exp_f32 v230, v126
    s_waitcnt lgkmcnt(5)
    v_mfma_f32_32x32x16_bf16 v[48:63], v[220:223], v[156:159], v[48:63]
    v_add_f32 v233, v233, v230
    v_exp_f32 v231, v127
    s_nop 0
    v_add_f32 v233, v233, v231
    v_cvt_pk_bf16_f32 v151, v230, v231
    v_cmp_ngt_f32 vcc, s63, v233
    s_cbranch_vccnz L_fb21
L_ret21:
    v_add_f32 v232, v232, v233
    s_waitcnt vmcnt(8) lgkmcnt(0)
    s_barrier
    v_mfma_f32_32x32x16_bf16 v[112:127], v[160:163], v[64:67], v[96:111]
    ds_read_b64_tr_b16 v[192:193], v235 offset:17408
    ds_read_b64_tr_b16 v[194:195], v235 offset:17664
    v_exp_f32 v224, v128
    s_add_u32 m0, s54, 0
    v_mfma_f32_32x32x16_bf16 v[112:127], v[164:167], v[68:71], v[112:127]
    ds_read_b64_tr_b16 v[196:197], v235 offset:17472
    ds_read_b64_tr_b16 v[198:199], v235 offset:17728
    buffer_load_dwordx4 v236, s[24:27], s59 offen nt lds
    v_exp_f32 v225, v129
    v_mfma_f32_32x32x16_bf16 v[112:127], v[168:171], v[72:75], v[112:127]
    ds_read_b64_tr_b16 v[200:201], v235 offset:17536
    ds_read_b64_tr_b16 v[202:203], v235 offset:17792
    v_add_f32 v233, v224, v225
    v_cvt_pk_bf16_f32 v152, v224, v225
    v_exp_f32 v226, v130
    v_mfma_f32_32x32x16_bf16 v[112:127], v[172:175], v[76:79], v[112:127]
    ds_read_b64_tr_b16 v[204:205], v235 offset:17600
    ds_read_b64_tr_b16 v[206:207], v235 offset:17856
    v_add_f32 v233, v233, v226
    v_exp_f32 v227, v131
    v_mfma_f32_32x32x16_bf16 v[112:127], v[176:179], v[80:83], v[112:127]
    ds_read_b64_tr_b16 v[208:209], v235 offset:17920
    ds_read_b64_tr_b16 v[210:211], v235 offset:18176
    ds_read_b128 v[160:163], v234 offset:8448
    v_add_f32 v233, v233, v227
    v_cvt_pk_bf16_f32 v153, v226, v227
    v_exp_f32 v228, v132
    s_add_u32 m0, s54, 800
    v_mfma_f32_32x32x16_bf16 v[112:127], v[180:183], v[84:87], v[112:127]
    ds_read_b64_tr_b16 v[212:213], v235 offset:17984
    ds_read_b64_tr_b16 v[214:215], v235 offset:18240
    ds_read_b128 v[164:167], v234 offset:8480
    buffer_load_dwordx4 v236, s[24:27], s59 offen offset:256 nt lds
    v_add_f32 v233, v233, v228
    v_exp_f32 v229, v133
    v_mfma_f32_32x32x16_bf16 v[112:127], v[184:187], v[88:91], v[112:127]
    ds_read_b64_tr_b16 v[216:217], v235 offset:18048
    ds_read_b64_tr_b16 v[218:219], v235 offset:18304
    ds_read_b128 v[168:171], v234 offset:8512
    v_add_f32 v233, v233, v229
    v_cvt_pk_bf16_f32 v154, v228, v229
    v_exp_f32 v230, v134
    v_mfma_f32_32x32x16_bf16 v[112:127], v[188:191], v[92:95], v[112:127]
    ds_read_b64_tr_b16 v[220:221], v235 offset:18112
    ds_read_b64_tr_b16 v[222:223], v235 offset:18368
    ds_read_b128 v[172:175], v234 offset:8544
    v_add_f32 v233, v233, v230
    v_exp_f32 v231, v135
    s_waitcnt lgkmcnt(15)
    v_mfma_f32_32x32x16_bf16 v[0:15], v[192:195], v[144:147], v[0:15]
    ds_read_b128 v[176:179], v234 offset:8576
    v_add_f32 v233, v233, v231
    v_cvt_pk_bf16_f32 v155, v230, v231
    v_exp_f32 v224, v136
    s_add_u32 m0, s55, 8704
    v_mfma_f32_32x32x16_bf16 v[16:31], v[196:199], v[144:147], v[16:31]
    ds_read_b128 v[180:183], v234 offset:8608
    s_add_u32 s59, s59, 8192
    s_and_b32 s59, s59, 0x1ffff
    buffer_load_dwordx4 v237, s[28:31], s60 offen nt lds
    v_add_f32 v233, v233, v224
    v_exp_f32 v225, v137
    s_waitcnt lgkmcnt(15)
    v_mfma_f32_32x32x16_bf16 v[32:47], v[200:203], v[144:147], v[32:47]
    ds_read_b128 v[184:187], v234 offset:8640
    v_add_f32 v233, v233, v225
    v_cvt_pk_bf16_f32 v156, v224, v225
    v_exp_f32 v226, v138
    s_waitcnt lgkmcnt(15)
    v_mfma_f32_32x32x16_bf16 v[48:63], v[204:207], v[144:147], v[48:63]
    ds_read_b128 v[188:191], v234 offset:8672
    v_add_f32 v233, v233, v226
    v_exp_f32 v227, v139
    s_waitcnt lgkmcnt(14)
    v_mfma_f32_32x32x16_bf16 v[0:15], v[208:211], v[148:151], v[0:15]
    v_add_f32 v233, v233, v227
    v_cvt_pk_bf16_f32 v157, v226, v227
    v_exp_f32 v228, v140
    s_add_u32 m0, s55, 9536
    s_waitcnt lgkmcnt(11)
    v_mfma_f32_32x32x16_bf16 v[16:31], v[212:215], v[148:151], v[16:31]
    buffer_load_dwordx4 v237, s[28:31], s60 offen offset:256 nt lds
    s_add_u32 s60, s60, 8192
    s_and_b32 s60, s60, 0x1ffff
    v_add_f32 v233, v233, v228
    v_exp_f32 v229, v141
    s_waitcnt lgkmcnt(8)
    v_mfma_f32_32x32x16_bf16 v[32:47], v[216:219], v[148:151], v[32:47]
    v_add_f32 v233, v233, v229
    v_cvt_pk_bf16_f32 v158, v228, v229
    v_exp_f32 v230, v142
    s_waitcnt lgkmcnt(5)
    v_mfma_f32_32x32x16_bf16 v[48:63], v[220:223], v[148:151], v[48:63]
    v_add_f32 v233, v233, v230
    v_exp_f32 v231, v143
    s_nop 0
    v_add_f32 v233, v233, v231
    v_cvt_pk_bf16_f32 v159, v230, v231
    v_cmp_ngt_f32 vcc, s63, v233
    s_cbranch_vccnz L_fb22
L_ret22:
    v_add_f32 v232, v232, v233
    s_waitcnt vmcnt(8) lgkmcnt(0)
    s_barrier
    v_mfma_f32_32x32x16_bf16 v[128:143], v[160:163], v[64:67], v[96:111]
    ds_read_b64_tr_b16 v[192:193], v235 offset:26112
    ds_read_b64_tr_b16 v[194:195], v235 offset:26368
    v_exp_f32 v224, v112
    s_add_u32 m0, s54, 8448
    v_mfma_f32_32x32x16_bf16 v[128:143], v[164:167], v[68:71], v[128:143]
    ds_read_b64_tr_b16 v[196:197], v235 offset:26176
    ds_read_b64_tr_b16 v[198:199], v235 offset:26432
    buffer_load_dwordx4 v236, s[24:27], s59 offen nt lds
    v_exp_f32 v225, v113
    v_mfma_f32_32x32x16_bf16 v[128:143], v[168:171], v[72:75], v[128:143]
    ds_read_b64_tr_b16 v[200:201], v235 offset:26240
    ds_read_b64_tr_b16 v[202:203], v235 offset:26496
    v_add_f32 v233, v224, v225
    v_cvt_pk_bf16_f32 v144, v224, v225
    v_exp_f32 v226, v114
    v_mfma_f32_32x32x16_bf16 v[128:143], v[172:175], v[76:79], v[128:143]
    ds_read_b64_tr_b16 v[204:205], v235 offset:26304
    ds_read_b64_tr_b16 v[206:207], v235 offset:26560
    v_add_f32 v233, v233, v226
    v_exp_f32 v227, v115
    v_mfma_f32_32x32x16_bf16 v[128:143], v[176:179], v[80:83], v[128:143]
    ds_read_b64_tr_b16 v[208:209], v235 offset:26624
    ds_read_b64_tr_b16 v[210:211], v235 offset:26880
    ds_read_b128 v[160:163], v234 offset:16896
    v_add_f32 v233, v233, v227
    v_cvt_pk_bf16_f32 v145, v226, v227
    v_exp_f32 v228, v116
    s_add_u32 m0, s54, 9248
    v_mfma_f32_32x32x16_bf16 v[128:143], v[180:183], v[84:87], v[128:143]
    ds_read_b64_tr_b16 v[212:213], v235 offset:26688
    ds_read_b64_tr_b16 v[214:215], v235 offset:26944
    ds_read_b128 v[164:167], v234 offset:16928
    buffer_load_dwordx4 v236, s[24:27], s59 offen offset:256 nt lds
    v_add_f32 v233, v233, v228
    v_exp_f32 v229, v117
    v_mfma_f32_32x32x16_bf16 v[128:143], v[184:187], v[88:91], v[128:143]
    ds_read_b64_tr_b16 v[216:217], v235 offset:26752
    ds_read_b64_tr_b16 v[218:219], v235 offset:27008
    ds_read_b128 v[168:171], v234 offset:16960
    v_add_f32 v233, v233, v229
    v_cvt_pk_bf16_f32 v146, v228, v229
    v_exp_f32 v230, v118
    v_mfma_f32_32x32x16_bf16 v[128:143], v[188:191], v[92:95], v[128:143]
    ds_read_b64_tr_b16 v[220:221], v235 offset:26816
    ds_read_b64_tr_b16 v[222:223], v235 offset:27072
    ds_read_b128 v[172:175], v234 offset:16992
    v_add_f32 v233, v233, v230
    v_exp_f32 v231, v119
    s_waitcnt lgkmcnt(15)
    v_mfma_f32_32x32x16_bf16 v[0:15], v[192:195], v[152:155], v[0:15]
    ds_read_b128 v[176:179], v234 offset:17024
    v_add_f32 v233, v233, v231
    v_cvt_pk_bf16_f32 v147, v230, v231
    v_exp_f32 v224, v120
    s_add_u32 m0, s55, 17408
    v_mfma_f32_32x32x16_bf16 v[16:31], v[196:199], v[152:155], v[16:31]
    ds_read_b128 v[180:183], v234 offset:17056
    s_add_u32 s59, s59, 8192
    s_and_b32 s59, s59, 0x1ffff
    buffer_load_dwordx4 v237, s[28:31], s60 offen nt lds
    v_add_f32 v233, v233, v224
    v_exp_f32 v225, v121
    s_waitcnt lgkmcnt(15)
    v_mfma_f32_32x32x16_bf16 v[32:47], v[200:203], v[152:155], v[32:47]
    ds_read_b128 v[184:187], v234 offset:17088
    v_add_f32 v233, v233, v225
    v_cvt_pk_bf16_f32 v148, v224, v225
    v_exp_f32 v226, v122
    s_waitcnt lgkmcnt(15)
    v_mfma_f32_32x32x16_bf16 v[48:63], v[204:207], v[152:155], v[48:63]
    ds_read_b128 v[188:191], v234 offset:17120
    v_add_f32 v233, v233, v226
    v_exp_f32 v227, v123
    s_waitcnt lgkmcnt(14)
    v_mfma_f32_32x32x16_bf16 v[0:15], v[208:211], v[156:159], v[0:15]
    v_add_f32 v233, v233, v227
    v_cvt_pk_bf16_f32 v149, v226, v227
    v_exp_f32 v228, v124
    s_add_u32 m0, s55, 18240
    s_waitcnt lgkmcnt(11)
    v_mfma_f32_32x32x16_bf16 v[16:31], v[212:215], v[156:159], v[16:31]
    buffer_load_dwordx4 v237, s[28:31], s60 offen offset:256 nt lds
    s_add_u32 s60, s60, 8192
    s_and_b32 s60, s60, 0x1ffff
    v_add_f32 v233, v233, v228
    v_exp_f32 v229, v125
    s_waitcnt lgkmcnt(8)
    v_mfma_f32_32x32x16_bf16 v[32:47], v[216:219], v[156:159], v[32:47]
    v_add_f32 v233, v233, v229
    v_cvt_pk_bf16_f32 v150, v228, v229
    v_exp_f32 v230, v126
    s_waitcnt lgkmcnt(5)
    v_mfma_f32_32x32x16_bf16 v[48:63], v[220:223], v[156:159], v[48:63]
    v_add_f32 v233, v233, v230
    v_exp_f32 v231, v127
    s_nop 0
    v_add_f32 v233, v233, v231
    v_cvt_pk_bf16_f32 v151, v230, v231
    v_cmp_ngt_f32 vcc, s63, v233
    s_cbranch_vccnz L_fb23
L_ret23:
    v_add_f32 v232, v232, v233
    s_waitcnt vmcnt(8) lgkmcnt(0)
    s_barrier
    v_mfma_f32_32x32x16_bf16 v[112:127], v[160:163], v[64:67], v[96:111]
    ds_read_b64_tr_b16 v[192:193], v235 offset:0
    ds_read_b64_tr_b16 v[194:195], v235 offset:256
    v_exp_f32 v224, v128
    s_add_u32 m0, s54, 16896
    v_mfma_f32_32x32x16_bf16 v[112:127], v[164:167], v[68:71], v[112:127]
    ds_read_b64_tr_b16 v[196:197], v235 offset:64
    ds_read_b64_tr_b16 v[198:199], v235 offset:320
    buffer_load_dwordx4 v236, s[24:27], s59 offen nt lds
    v_exp_f32 v225, v129
    v_mfma_f32_32x32x16_bf16 v[112:127], v[168:171], v[72:75], v[112:127]
    ds_read_b64_tr_b16 v[200:201], v235 offset:128
    ds_read_b64_tr_b16 v[202:203], v235 offset:384
    v_add_f32 v233, v224, v225
    v_cvt_pk_bf16_f32 v152, v224, v225
    v_exp_f32 v226, v130
    v_mfma_f32_32x32x16_bf16 v[112:127], v[172:175], v[76:79], v[112:127]
    ds_read_b64_tr_b16 v[204:205], v235 offset:192
    ds_read_b64_tr_b16 v[206:207], v235 offset:448
    v_add_f32 v233, v233, v226
    v_exp_f32 v227, v131
    v_mfma_f32_32x32x16_bf16 v[112:127], v[176:179], v[80:83], v[112:127]
    ds_read_b64_tr_b16 v[208:209], v235 offset:512
    ds_read_b64_tr_b16 v[210:211], v235 offset:768
    ds_read_b128 v[160:163], v234 offset:25344
    v_add_f32 v233, v233, v227
    v_cvt_pk_bf16_f32 v153, v226, v227
    v_exp_f32 v228, v132
    s_add_u32 m0, s54, 17696
    v_mfma_f32_32x32x16_bf16 v[112:127], v[180:183], v[84:87], v[112:127]
    ds_read_b64_tr_b16 v[212:213], v235 offset:576
    ds_read_b64_tr_b16 v[214:215], v235 offset:832
    ds_read_b128 v[164:167], v234 offset:25376
    buffer_load_dwordx4 v236, s[24:27], s59 offen offset:256 nt lds
    v_add_f32 v233, v233, v228
    v_exp_f32 v229, v133
    v_mfma_f32_32x32x16_bf16 v[112:127], v[184:187], v[88:91], v[112:127]
    ds_read_b64_tr_b16 v[216:217], v235 offset:640
    ds_read_b64_tr_b16 v[218:219], v235 offset:896
    ds_read_b128 v[168:171], v234 offset:25408
    v_add_f32 v233, v233, v229
    v_cvt_pk_bf16_f32 v154, v228, v229
    v_exp_f32 v230, v134
    v_mfma_f32_32x32x16_bf16 v[112:127], v[188:191], v[92:95], v[112:127]
    ds_read_b64_tr_b16 v[220:221], v235 offset:704
    ds_read_b64_tr_b16 v[222:223], v235 offset:960
    ds_read_b128 v[172:175], v234 offset:25440
    v_add_f32 v233, v233, v230
    v_exp_f32 v231, v135
    s_waitcnt lgkmcnt(15)
    v_mfma_f32_32x32x16_bf16 v[0:15], v[192:195], v[144:147], v[0:15]
    ds_read_b128 v[176:179], v234 offset:25472
    v_add_f32 v233, v233, v231
    v_cvt_pk_bf16_f32 v155, v230, v231
    v_exp_f32 v224, v136
    s_add_u32 m0, s55, 26112
    v_mfma_f32_32x32x16_bf16 v[16:31], v[196:199], v[144:147], v[16:31]
    ds_read_b128 v[180:183], v234 offset:25504
    s_add_u32 s59, s59, 8192
    s_and_b32 s59, s59, 0x1ffff
    buffer_load_dwordx4 v237, s[28:31], s60 offen nt lds
    v_add_f32 v233, v233, v224
    v_exp_f32 v225, v137
    s_waitcnt lgkmcnt(15)
    v_mfma_f32_32x32x16_bf16 v[32:47], v[200:203], v[144:147], v[32:47]
    ds_read_b128 v[184:187], v234 offset:25536
    v_add_f32 v233, v233, v225
    v_cvt_pk_bf16_f32 v156, v224, v225
    v_exp_f32 v226, v138
    s_waitcnt lgkmcnt(15)
    v_mfma_f32_32x32x16_bf16 v[48:63], v[204:207], v[144:147], v[48:63]
    ds_read_b128 v[188:191], v234 offset:25568
    v_add_f32 v233, v233, v226
    v_exp_f32 v227, v139
    s_waitcnt lgkmcnt(14)
    v_mfma_f32_32x32x16_bf16 v[0:15], v[208:211], v[148:151], v[0:15]
    v_add_f32 v233, v233, v227
    v_cvt_pk_bf16_f32 v157, v226, v227
    v_exp_f32 v228, v140
    s_add_u32 m0, s55, 26944
    s_waitcnt lgkmcnt(11)
    v_mfma_f32_32x32x16_bf16 v[16:31], v[212:215], v[148:151], v[16:31]
    buffer_load_dwordx4 v237, s[28:31], s60 offen offset:256 nt lds
    s_add_u32 s60, s60, 8192
    s_and_b32 s60, s60, 0x1ffff
    v_add_f32 v233, v233, v228
    v_exp_f32 v229, v141
    s_waitcnt lgkmcnt(8)
    v_mfma_f32_32x32x16_bf16 v[32:47], v[216:219], v[148:151], v[32:47]
    v_add_f32 v233, v233, v229
    v_cvt_pk_bf16_f32 v158, v228, v229
    v_exp_f32 v230, v142
    s_waitcnt lgkmcnt(5)
    v_mfma_f32_32x32x16_bf16 v[48:63], v[220:223], v[148:151], v[48:63]
    v_add_f32 v233, v233, v230
    v_exp_f32 v231, v143
    s_nop 0
    v_add_f32 v233, v233, v231
    v_cvt_pk_bf16_f32 v159, v230, v231
    v_cmp_ngt_f32 vcc, s63, v233
    s_cbranch_vccnz L_fb20
L_ret20:
    v_add_f32 v232, v232, v233
    s_sub_u32 s61, s61, 1
    s_cmp_lg_u32 s61, 0
    s_cbranch_scc1 L_f_at_loop1
    s_waitcnt vmcnt(8) lgkmcnt(0)
    s_barrier
    v_mfma_f32_32x32x16_bf16 v[128:143], v[160:163], v[64:67], v[96:111]
    ds_read_b64_tr_b16 v[192:193], v235 offset:8704
    ds_read_b64_tr_b16 v[194:195], v235 offset:8960
    v_exp_f32 v224, v112
    s_add_u32 m0, s54, 25344
    v_mfma_f32_32x32x16_bf16 v[128:143], v[164:167], v[68:71], v[128:143]
    ds_read_b64_tr_b16 v[196:197], v235 offset:8768
    ds_read_b64_tr_b16 v[198:199], v235 offset:9024
    buffer_load_dwordx4 v236, s[24:27], s59 offen nt lds
    v_exp_f32 v225, v113
    v_mfma_f32_32x32x16_bf16 v[128:143], v[168:171], v[72:75], v[128:143]
    ds_read_b64_tr_b16 v[200:201], v235 offset:8832
    ds_read_b64_tr_b16 v[202:203], v235 offset:9088
    v_add_f32 v233, v224, v225
    v_cvt_pk_bf16_f32 v144, v224, v225
    v_exp_f32 v226, v114
    v_mfma_f32_32x32x16_bf16 v[128:143], v[172:175], v[76:79], v[128:143]
    ds_read_b64_tr_b16 v[204:205], v235 offset:8896
    ds_read_b64_tr_b16 v[206:207], v235 offset:9152
    v_add_f32 v233, v233, v226
    v_exp_f32 v227, v115
    v_mfma_f32_32x32x16_bf16 v[128:143], v[176:179], v[80:83], v[128:143]
    ds_read_b64_tr_b16 v[208:209], v235 offset:9216
    ds_read_b64_tr_b16 v[210:211], v235 offset:9472
    ds_read_b128 v[160:163], v234 offset:0
    v_add_f32 v233, v233, v227
    v_cvt_pk_bf16_f32 v145, v226, v227
    v_exp_f32 v228, v116
    s_add_u32 m0, s54, 26144
    v_mfma_f32_32x32x16_bf16 v[128:143], v[180:183], v[84:87], v[128:143]
    ds_read_b64_tr_b16 v[212:213], v235 offset:9280
    ds_read_b64_tr_b16 v[214:215], v235 offset:9536
    ds_read_b128 v[164:167], v234 offset:32
    buffer_load_dwordx4 v236, s[24:27], s59 offen offset:256 nt lds
    v_add_f32 v233, v233, v228
    v_exp_f32 v229, v117
    v_mfma_f32_32x32x16_bf16 v[128:143], v[184:187], v[88:91], v[128:143]
    ds_read_b64_tr_b16 v[216:217], v235 offset:9344
    ds_read_b64_tr_b16 v[218:219], v235 offset:9600
    ds_read_b128 v[168:171], v234 offset:64
    v_add_f32 v233, v233, v229
    v_cvt_pk_bf16_f32 v146, v228, v229
    v_exp_f32 v230, v118
    v_mfma_f32_32x32x16_bf16 v[128:143], v[188:191], v[92:95], v[128:143]
    ds_read_b64_tr_b16 v[220:221], v235 offset:9408
    ds_read_b64_tr_b16 v[222:223], v235 offset:9664
    ds_read_b128 v[172:175], v234 offset:96
    v_add_f32 v233, v233, v230
    v_exp_f32 v231, v119
    s_waitcnt lgkmcnt(15)
    v_mfma_f32_32x32x16_bf16 v[0:15], v[192:195], v[152:155], v[0:15]
    ds_read_b128 v[176:179], v234 offset:128
    v_add_f32 v233, v233, v231
    v_cvt_pk_bf16_f32 v147, v230, v231
    v_exp_f32 v224, v120
    s_add_u32 m0, s55, 0
    v_mfma_f32_32x32x16_bf16 v[16:31], v[196:199], v[152:155], v[16:31]
    ds_read_b128 v[180:183], v234 offset:160
    s_add_u32 s59, s59, 8192
    s_and_b32 s59, s59, 0x1ffff
    buffer_load_dwordx4 v237, s[28:31], s60 offen nt lds
    v_add_f32 v233, v233, v224
    v_exp_f32 v225, v121
    s_waitcnt lgkmcnt(15)
    v_mfma_f32_32x32x16_bf16 v[32:47], v[200:203], v[152:155], v[32:47]
    ds_read_b128 v[184:187], v234 offset:192
    v_add_f32 v233, v233, v225
    v_cvt_pk_bf16_f32 v148, v224, v225
    v_exp_f32 v226, v122
    s_waitcnt lgkmcnt(15)
    v_mfma_f32_32x32x16_bf16 v[48:63], v[204:207], v[152:155], v[48:63]
    ds_read_b128 v[188:191], v234 offset:224
    v_add_f32 v233, v233, v226
    v_exp_f32 v227, v123
    s_waitcnt lgkmcnt(14)
    v_mfma_f32_32x32x16_bf16 v[0:15], v[208:211], v[156:159], v[0:15]
    v_add_f32 v233, v233, v227
    v_cvt_pk_bf16_f32 v149, v226, v227
    v_exp_f32 v228, v124
    s_add_u32 m0, s55, 832
    s_waitcnt lgkmcnt(11)
    v_mfma_f32_32x32x16_bf16 v[16:31], v[212:215], v[156:159], v[16:31]
    buffer_load_dwordx4 v237, s[28:31], s60 offen offset:256 nt lds
    s_add_u32 s60, s60, 8192
    s_and_b32 s60, s60, 0x1ffff
    v_add_f32 v233, v233, v228
    v_exp_f32 v229, v125
    s_waitcnt lgkmcnt(8)
    v_mfma_f32_32x32x16_bf16 v[32:47], v[216:219], v[156:159], v[32:47]
    v_add_f32 v233, v233, v229
    v_cvt_pk_bf16_f32 v150, v228, v229
    v_exp_f32 v230, v126
    s_waitcnt lgkmcnt(5)
    v_mfma_f32_32x32x16_bf16 v[48:63], v[220:223], v[156:159], v[48:63]
    v_add_f32 v233, v233, v230
    v_exp_f32 v231, v127
    s_nop 0
    v_add_f32 v233, v233, v231
    v_cvt_pk_bf16_f32 v151, v230, v231
    v_cmp_ngt_f32 vcc, s63, v233
    s_cbranch_vccnz L_fb9
L_ret9:
    v_add_f32 v232, v232, v233
    s_waitcnt vmcnt(8) lgkmcnt(0)
    s_barrier
    v_mfma_f32_32x32x16_bf16 v[112:127], v[160:163], v[64:67], v[96:111]
    ds_read_b64_tr_b16 v[192:193], v235 offset:17408
    ds_read_b64_tr_b16 v[194:195], v235 offset:17664
    v_exp_f32 v224, v128
    s_add_u32 m0, s55, 8704
    v_mfma_f32_32x32x16_bf16 v[112:127], v[164:167], v[68:71], v[112:127]
    ds_read_b64_tr_b16 v[196:197], v235 offset:17472
    ds_read_b64_tr_b16 v[198:199], v235 offset:17728
    buffer_load_dwordx4 v237, s[28:31], s60 offen nt lds
    v_exp_f32 v225, v129
    v_mfma_f32_32x32x16_bf16 v[112:127], v[168:171], v[72:75], v[112:127]
    ds_read_b64_tr_b16 v[200:201], v235 offset:17536
    ds_read_b64_tr_b16 v[202:203], v235 offset:17792
    v_add_f32 v233, v224, v225
    v_cvt_pk_bf16_f32 v152, v224, v225
    v_exp_f32 v226, v130
    v_mfma_f32_32x32x16_bf16 v[112:127], v[172:175], v[76:79], v[112:127]
    ds_read_b64_tr_b16 v[204:205], v235 offset:17600
    ds_read_b64_tr_b16 v[206:207], v235 offset:17856
    v_add_f32 v233, v233, v226
    v_exp_f32 v227, v131
    v_mfma_f32_32x32x16_bf16 v[112:127], v[176:179], v[80:83], v[112:127]
    ds_read_b64_tr_b16 v[208:209], v235 offset:17920
    ds_read_b64_tr_b16 v[210:211], v235 offset:18176
    ds_read_b128 v[160:163], v234 offset:8448
    v_add_f32 v233, v233, v227
    v_cvt_pk_bf16_f32 v153, v226, v227
    v_exp_f32 v228, v132
    s_add_u32 m0, s55, 9536
    v_mfma_f32_32x32x16_bf16 v[112:127], v[180:183], v[84:87], v[112:127]
    ds_read_b64_tr_b16 v[212:213], v235 offset:17984
    ds_read_b64_tr_b16 v[214:215], v235 offset:18240
    ds_read_b128 v[164:167], v234 offset:8480
    buffer_load_dwordx4 v237, s[28:31], s60 offen offset:256 nt lds
    s_add_u32 s60, s60, 8192
    s_and_b32 s60, s60, 0x1ffff
    v_add_f32 v233, v233, v228
    v_exp_f32 v229, v133
    v_mfma_f32_32x32x16_bf16 v[112:127], v[184:187], v[88:91], v[112:127]
    ds_read_b64_tr_b16 v[216:217], v235 offset:18048
    ds_read_b64_tr_b16 v[218:219], v235 offset:18304
    ds_read_b128 v[168:171], v234 offset:8512
    v_add_f32 v233, v233, v229
    v_cvt_pk_bf16_f32 v154, v228, v229
    v_exp_f32 v230, v134
    v_mfma_f32_32x32x16_bf16 v[112:127], v[188:191], v[92:95], v[112:127]
    ds_read_b64_tr_b16 v[220:221], v235 offset:18112
    ds_read_b64_tr_b16 v[222:223], v235 offset:18368
    ds_read_b128 v[172:175], v234 offset:8544
    v_add_f32 v233, v233, v230
    v_exp_f32 v231, v135
    s_waitcnt lgkmcnt(15)
    v_mfma_f32_32x32x16_bf16 v[0:15], v[192:195], v[144:147], v[0:15]
    ds_read_b128 v[176:179], v234 offset:8576
    v_add_f32 v233, v233, v231
    v_cvt_pk_bf16_f32 v155, v230, v231
    v_exp_f32 v224, v136
    v_mfma_f32_32x32x16_bf16 v[16:31], v[196:199], v[144:147], v[16:31]
    ds_read_b128 v[180:183], v234 offset:8608
    v_add_f32 v233, v233, v224
    v_exp_f32 v225, v137
    s_waitcnt lgkmcnt(15)
    v_mfma_f32_32x32x16_bf16 v[32:47], v[200:203], v[144:147], v[32:47]
    ds_read_b128 v[184:187], v234 offset:8640
    v_add_f32 v233, v233, v225
    v_cvt_pk_bf16_f32 v156, v224, v225
    v_exp_f32 v226, v138
    s_waitcnt lgkmcnt(15)
    v_mfma_f32_32x32x16_bf16 v[48:63], v[204:207], v[144:147], v[48:63]
    ds_read_b128 v[188:191], v234 offset:8672
    v_add_f32 v233, v233, v226
    v_exp_f32 v227, v139
    s_waitcnt lgkmcnt(14)
    v_mfma_f32_32x32x16_bf16 v[0:15], v[208:211], v[148:151], v[0:15]
    v_add_f32 v233, v233, v227
    v_cvt_pk_bf16_f32 v157, v226, v227
    v_exp_f32 v228, v140
    s_waitcnt lgkmcnt(11)
    v_mfma_f32_32x32x16_bf16 v[16:31], v[212:215], v[148:151], v[16:31]
    v_add_f32 v233, v233, v228
    v_exp_f32 v229, v141
    s_waitcnt lgkmcnt(8)
    v_mfma_f32_32x32x16_bf16 v[32:47], v[216:219], v[148:151], v[32:47]
    v_add_f32 v233, v233, v229
    v_cvt_pk_bf16_f32 v158, v228, v229
    v_exp_f32 v230, v142
    s_waitcnt lgkmcnt(5)
    v_mfma_f32_32x32x16_bf16 v[48:63], v[220:223], v[148:151], v[48:63]
    v_add_f32 v233, v233, v230
    v_exp_f32 v231, v143
    s_nop 0
    v_add_f32 v233, v233, v231
    v_cvt_pk_bf16_f32 v159, v230, v231
    v_cmp_ngt_f32 vcc, s63, v233
    s_cbranch_vccnz L_fb10
L_ret10:
    v_add_f32 v232, v232, v233
    s_waitcnt vmcnt(6) lgkmcnt(0)
    s_barrier
    v_mfma_f32_32x32x16_bf16 v[128:143], v[160:163], v[64:67], v[96:111]
    ds_read_b64_tr_b16 v[192:193], v235 offset:26112
    ds_read_b64_tr_b16 v[194:195], v235 offset:26368
    v_exp_f32 v224, v112
    s_add_u32 m0, s55, 17408
    v_mfma_f32_32x32x16_bf16 v[128:143], v[164:167], v[68:71], v[128:143]
    ds_read_b64_tr_b16 v[196:197], v235 offset:26176
    ds_read_b64_tr_b16 v[198:199], v235 offset:26432
    buffer_load_dwordx4 v237, s[28:31], s60 offen nt lds
    v_exp_f32 v225, v113
    v_mfma_f32_32x32x16_bf16 v[128:143], v[168:171], v[72:75], v[128:143]
    ds_read_b64_tr_b16 v[200:201], v235 offset:26240
    ds_read_b64_tr_b16 v[202:203], v235 offset:26496
    v_add_f32 v233, v224, v225
    v_cvt_pk_bf16_f32 v144, v224, v225
    v_exp_f32 v226, v114
    v_mfma_f32_32x32x16_bf16 v[128:143], v[172:175], v[76:79], v[128:143]
    ds_read_b64_tr_b16 v[204:205], v235 offset:26304
    ds_read_b64_tr_b16 v[206:207], v235 offset:26560
    v_add_f32 v233, v233, v226
    v_exp_f32 v227, v115
    v_mfma_f32_32x32x16_bf16 v[128:143], v[176:179], v[80:83], v[128:143]
    ds_read_b64_tr_b16 v[208:209], v235 offset:26624
    ds_read_b64_tr_b16 v[210:211], v235 offset:26880
    ds_read_b128 v[160:163], v234 offset:16896
    v_add_f32 v233, v233, v227
    v_cvt_pk_bf16_f32 v145, v226, v227
    v_exp_f32 v228, v116
    s_add_u32 m0, s55, 18240
    v_mfma_f32_32x32x16_bf16 v[128:143], v[180:183], v[84:87], v[128:143]
    ds_read_b64_tr_b16 v[212:213], v235 offset:26688
    ds_read_b64_tr_b16 v[214:215], v235 offset:26944
    ds_read_b128 v[164:167], v234 offset:16928
    buffer_load_dwordx4 v237, s[28:31], s60 offen offset:256 nt lds
    v_add_f32 v233, v233, v228
    v_exp_f32 v229, v117
    v_mfma_f32_32x32x16_bf16 v[128:143], v[184:187], v[88:91], v[128:143]
    ds_read_b64_tr_b16 v[216:217], v235 offset:26752
    ds_read_b64_tr_b16 v[218:219], v235 offset:27008
    ds_read_b128 v[168:171], v234 offset:16960
    v_add_f32 v233, v233, v229
    v_cvt_pk_bf16_f32 v146, v228, v229
    v_exp_f32 v230, v118
    v_mfma_f32_32x32x16_bf16 v[128:143], v[188:191], v[92:95], v[128:143]
    ds_read_b64_tr_b16 v[220:221], v235 offset:26816
    ds_read_b64_tr_b16 v[222:223], v235 offset:27072
    ds_read_b128 v[172:175], v234 offset:16992
    v_add_f32 v233, v233, v230
    v_exp_f32 v231, v119
    s_waitcnt lgkmcnt(15)
    v_mfma_f32_32x32x16_bf16 v[0:15], v[192:195], v[152:155], v[0:15]
    ds_read_b128 v[176:179], v234 offset:17024
    v_add_f32 v233, v233, v231
    v_cvt_pk_bf16_f32 v147, v230, v231
    v_exp_f32 v224, v120
    v_mfma_f32_32x32x16_bf16 v[16:31], v[196:199], v[152:155], v[16:31]
    ds_read_b128 v[180:183], v234 offset:17056
    s_add_u32 s60, s60, 8192
    s_and_b32 s60, s60, 0x1ffff
    s_lshr_b32 s51, s101, 3
    s_lshl_b32 s52, s98, 2
    s_add_u32 s51, s51, s52
    s_lshl_b32 s51, s51, 1
    s_add_u32 s51, s51, s97
    s_lshl_b32 s51, s51, 3
    s_and_b32 s52, s101, 7
    s_add_u32 s51, s51, s52
    s_lshl_b32 s51, s51, 2
    s_add_u32 s51, s51, s96
    s_mul_i32 s51, s51, 5120
    v_mul_u32_u24 v247, 80, v243
    buffer_load_dword v246, v247, s[36:39], s51 offen
    v_add_f32 v233, v233, v224
    v_exp_f32 v225, v121
    s_waitcnt lgkmcnt(15)
    v_mfma_f32_32x32x16_bf16 v[32:47], v[200:203], v[152:155], v[32:47]
    ds_read_b128 v[184:187], v234 offset:17088
    v_add_f32 v233, v233, v225
    v_cvt_pk_bf16_f32 v148, v224, v225
    v_exp_f32 v226, v122
    s_waitcnt lgkmcnt(15)
    v_mfma_f32_32x32x16_bf16 v[48:63], v[204:207], v[152:155], v[48:63]
    ds_read_b128 v[188:191], v234 offset:17120
    v_add_f32 v233, v233, v226
    v_exp_f32 v227, v123
    s_waitcnt lgkmcnt(14)
    v_mfma_f32_32x32x16_bf16 v[0:15], v[208:211], v[156:159], v[0:15]
    v_add_f32 v233, v233, v227
    v_cvt_pk_bf16_f32 v149, v226, v227
    v_exp_f32 v228, v124
    s_waitcnt lgkmcnt(11)
    v_mfma_f32_32x32x16_bf16 v[16:31], v[212:215], v[156:159], v[16:31]
    v_add_f32 v233, v233, v228
    v_exp_f32 v229, v125
    s_waitcnt lgkmcnt(8)
    v_mfma_f32_32x32x16_bf16 v[32:47], v[216:219], v[156:159], v[32:47]
    v_add_f32 v233, v233, v229
    v_cvt_pk_bf16_f32 v150, v228, v229
    v_exp_f32 v230, v126
    s_waitcnt lgkmcnt(5)
    v_mfma_f32_32x32x16_bf16 v[48:63], v[220:223], v[156:159], v[48:63]
    v_add_f32 v233, v233, v230
    v_exp_f32 v231, v127
    s_nop 0
    v_add_f32 v233, v233, v231
    v_cvt_pk_bf16_f32 v151, v230, v231
    v_cmp_ngt_f32 vcc, s63, v233
    s_cbranch_vccnz L_fb11
L_ret11:
    v_add_f32 v232, v232, v233
    s_waitcnt vmcnt(5) lgkmcnt(0)
    s_barrier
    v_mfma_f32_32x32x16_bf16 v[112:127], v[160:163], v[64:67], v[96:111]
    ds_read_b64_tr_b16 v[192:193], v235 offset:0
    ds_read_b64_tr_b16 v[194:195], v235 offset:256
    v_exp_f32 v224, v128
    s_add_u32 m0, s55, 26112
    v_mfma_f32_32x32x16_bf16 v[112:127], v[164:167], v[68:71], v[112:127]
    ds_read_b64_tr_b16 v[196:197], v235 offset:64
    ds_read_b64_tr_b16 v[198:199], v235 offset:320
    buffer_load_dwordx4 v237, s[28:31], s60 offen nt lds
    v_exp_f32 v225, v129
    v_mfma_f32_32x32x16_bf16 v[112:127], v[168:171], v[72:75], v[112:127]
    ds_read_b64_tr_b16 v[200:201], v235 offset:128
    ds_read_b64_tr_b16 v[202:203], v235 offset:384
    v_add_f32 v233, v224, v225
    v_cvt_pk_bf16_f32 v152, v224, v225
    v_exp_f32 v226, v130
    v_mfma_f32_32x32x16_bf16 v[112:127], v[172:175], v[76:79], v[112:127]
    ds_read_b64_tr_b16 v[204:205], v235 offset:192
    ds_read_b64_tr_b16 v[206:207], v235 offset:448
    v_add_f32 v233, v233, v226
    v_exp_f32 v227, v131
    v_mfma_f32_32x32x16_bf16 v[112:127], v[176:179], v[80:83], v[112:127]
    ds_read_b64_tr_b16 v[208:209], v235 offset:512
    ds_read_b64_tr_b16 v[210:211], v235 offset:768
    ds_read_b128 v[160:163], v234 offset:25344
    v_add_f32 v233, v233, v227
    v_cvt_pk_bf16_f32 v153, v226, v227
    v_exp_f32 v228, v132
    s_add_u32 m0, s55, 26944
    v_mfma_f32_32x32x16_bf16 v[112:127], v[180:183], v[84:87], v[112:127]
    ds_read_b64_tr_b16 v[212:213], v235 offset:576
    ds_read_b64_tr_b16 v[214:215], v235 offset:832
    ds_read_b128 v[164:167], v234 offset:25376
    buffer_load_dwordx4 v237, s[28:31], s60 offen offset:256 nt lds
    s_add_u32 s60, s60, 8192
    s_and_b32 s60, s60, 0x1ffff
    v_add_f32 v233, v233, v228
    v_exp_f32 v229, v133
    v_mfma_f32_32x32x16_bf16 v[112:127], v[184:187], v[88:91], v[112:127]
    ds_read_b64_tr_b16 v[216:217], v235 offset:640
    ds_read_b64_tr_b16 v[218:219], v235 offset:896
    ds_read_b128 v[168:171], v234 offset:25408
    v_add_f32 v233, v233, v229
    v_cvt_pk_bf16_f32 v154, v228, v229
    v_exp_f32 v230, v134
    v_mfma_f32_32x32x16_bf16 v[112:127], v[188:191], v[92:95], v[112:127]
    ds_read_b64_tr_b16 v[220:221], v235 offset:704
    ds_read_b64_tr_b16 v[222:223], v235 offset:960
    ds_read_b128 v[172:175], v234 offset:25440
    v_add_f32 v233, v233, v230
    v_exp_f32 v231, v135
    s_waitcnt lgkmcnt(15)
    v_mfma_f32_32x32x16_bf16 v[0:15], v[192:195], v[144:147], v[0:15]
    ds_read_b128 v[176:179], v234 offset:25472
    v_add_f32 v233, v233, v231
    v_cvt_pk_bf16_f32 v155, v230, v231
    v_exp_f32 v224, v136
    v_mfma_f32_32x32x16_bf16 v[16:31], v[196:199], v[144:147], v[16:31]
    ds_read_b128 v[180:183], v234 offset:25504
    v_add_f32 v233, v233, v224
    v_exp_f32 v225, v137
    s_waitcnt lgkmcnt(15)
    v_mfma_f32_32x32x16_bf16 v[32:47], v[200:203], v[144:147], v[32:47]
    ds_read_b128 v[184:187], v234 offset:25536
    v_add_f32 v233, v233, v225
    v_cvt_pk_bf16_f32 v156, v224, v225
    v_exp_f32 v226, v138
    s_waitcnt lgkmcnt(15)
    v_mfma_f32_32x32x16_bf16 v[48:63], v[204:207], v[144:147], v[48:63]
    ds_read_b128 v[188:191], v234 offset:25568
    v_add_f32 v233, v233, v226
    v_exp_f32 v227, v139
    s_waitcnt lgkmcnt(14)
    v_mfma_f32_32x32x16_bf16 v[0:15], v[208:211], v[148:151], v[0:15]
    v_add_f32 v233, v233, v227
    v_cvt_pk_bf16_f32 v157, v226, v227
    v_exp_f32 v228, v140
    s_waitcnt lgkmcnt(11)
    v_mfma_f32_32x32x16_bf16 v[16:31], v[212:215], v[148:151], v[16:31]
    v_add_f32 v233, v233, v228
    v_exp_f32 v229, v141
    s_waitcnt lgkmcnt(8)
    v_mfma_f32_32x32x16_bf16 v[32:47], v[216:219], v[148:151], v[32:47]
    v_add_f32 v233, v233, v229
    v_cvt_pk_bf16_f32 v158, v228, v229
    v_exp_f32 v230, v142
    s_waitcnt lgkmcnt(5)
    v_mfma_f32_32x32x16_bf16 v[48:63], v[220:223], v[148:151], v[48:63]
    v_add_f32 v233, v233, v230
    v_exp_f32 v231, v143
    s_nop 0
    v_add_f32 v233, v233, v231
    v_cvt_pk_bf16_f32 v159, v230, v231
    v_cmp_ngt_f32 vcc, s63, v233
    s_cbranch_vccnz L_fb12
L_ret12:
    v_add_f32 v232, v232, v233
    s_waitcnt vmcnt(5) lgkmcnt(0)
    s_barrier
    v_mfma_f32_32x32x16_bf16 v[128:143], v[160:163], v[64:67], v[96:111]
    ds_read_b64_tr_b16 v[192:193], v235 offset:8704
    ds_read_b64_tr_b16 v[194:195], v235 offset:8960
    v_exp_f32 v224, v112
    s_add_u32 m0, s66, 0
    v_mfma_f32_32x32x16_bf16 v[128:143], v[164:167], v[68:71], v[128:143]
    ds_read_b64_tr_b16 v[196:197], v235 offset:8768
    ds_read_b64_tr_b16 v[198:199], v235 offset:9024
    s_mov_b32 s51, s99
    s_and_b32 s51, s51, 3
    s_lshl_b32 s51, s51, 1
    s_add_u32 s51, s51, s97
    s_xor_b32 s51, s51, s68
    s_mul_i32 s51, s51, 163840
    s_add_u32 s57, s51, s65
    s_add_u32 s58, s57, 81920
    buffer_load_dwordx4 v251, s[36:39], s57 offen lds
    v_exp_f32 v225, v113
    v_mfma_f32_32x32x16_bf16 v[128:143], v[168:171], v[72:75], v[128:143]
    ds_read_b64_tr_b16 v[200:201], v235 offset:8832
    ds_read_b64_tr_b16 v[202:203], v235 offset:9088
    v_add_f32 v233, v224, v225
    v_cvt_pk_bf16_f32 v144, v224, v225
    v_exp_f32 v226, v114
    v_mfma_f32_32x32x16_bf16 v[128:143], v[172:175], v[76:79], v[128:143]
    ds_read_b64_tr_b16 v[204:205], v235 offset:8896
    ds_read_b64_tr_b16 v[206:207], v235 offset:9152
    v_add_f32 v233, v233, v226
    v_exp_f32 v227, v115
    s_add_u32 m0, s66, 1024
    v_mfma_f32_32x32x16_bf16 v[128:143], v[176:179], v[80:83], v[128:143]
    ds_read_b64_tr_b16 v[208:209], v235 offset:9216
    ds_read_b64_tr_b16 v[210:211], v235 offset:9472
    buffer_load_dwordx4 v252, s[36:39], s57 offen lds
    v_add_f32 v233, v233, v227
    v_cvt_pk_bf16_f32 v145, v226, v227
    v_exp_f32 v228, v116
    v_mfma_f32_32x32x16_bf16 v[128:143], v[180:183], v[84:87], v[128:143]
    ds_read_b64_tr_b16 v[212:213], v235 offset:9280
    ds_read_b64_tr_b16 v[214:215], v235 offset:9536
    v_add_f32 v233, v233, v228
    v_exp_f32 v229, v117
    v_mfma_f32_32x32x16_bf16 v[128:143], v[184:187], v[88:91], v[128:143]
    ds_read_b64_tr_b16 v[216:217], v235 offset:9344
    ds_read_b64_tr_b16 v[218:219], v235 offset:9600
    v_add_f32 v233, v233, v229
    v_cvt_pk_bf16_f32 v146, v228, v229
    v_exp_f32 v230, v118
    s_add_u32 m0, s66, 2048
    v_mfma_f32_32x32x16_bf16 v[128:143], v[188:191], v[92:95], v[128:143]
    ds_read_b64_tr_b16 v[220:221], v235 offset:9408
    ds_read_b64_tr_b16 v[222:223], v235 offset:9664
    buffer_load_dwordx4 v253, s[36:39], s57 offen lds
    v_add_f32 v233, v233, v230
    v_exp_f32 v231, v119
    s_waitcnt lgkmcnt(14)
    v_mfma_f32_32x32x16_bf16 v[0:15], v[192:195], v[152:155], v[0:15]
    v_add_f32 v233, v233, v231
    v_cvt_pk_bf16_f32 v147, v230, v231
    v_exp_f32 v224, v120
    s_waitcnt lgkmcnt(12)
    v_mfma_f32_32x32x16_bf16 v[16:31], v[196:199], v[152:155], v[16:31]
    v_add_f32 v233, v233, v224
    v_exp_f32 v225, v121
    s_add_u32 m0, s66, 3072
    s_waitcnt lgkmcnt(10)
    v_mfma_f32_32x32x16_bf16 v[32:47], v[200:203], v[152:155], v[32:47]
    buffer_load_dwordx4 v254, s[36:39], s57 offen lds
    v_add_f32 v233, v233, v225
    v_cvt_pk_bf16_f32 v148, v224, v225
    v_exp_f32 v226, v122
    s_waitcnt lgkmcnt(8)
    v_mfma_f32_32x32x16_bf16 v[48:63], v[204:207], v[152:155], v[48:63]
    v_add_f32 v233, v233, v226
    v_exp_f32 v227, v123
    s_waitcnt lgkmcnt(6)
    v_mfma_f32_32x32x16_bf16 v[0:15], v[208:211], v[156:159], v[0:15]
    v_add_f32 v233, v233, v227
    v_cvt_pk_bf16_f32 v149, v226, v227
    v_exp_f32 v228, v124
    s_add_u32 m0, s66, 4096
    s_waitcnt lgkmcnt(4)
    v_mfma_f32_32x32x16_bf16 v[16:31], v[212:215], v[156:159], v[16:31]
    buffer_load_dwordx4 v255, s[36:39], s57 offen lds
    v_add_f32 v233, v233, v228
    v_exp_f32 v229, v125
    s_waitcnt lgkmcnt(2)
    v_mfma_f32_32x32x16_bf16 v[32:47], v[216:219], v[156:159], v[32:47]
    v_add_f32 v233, v233, v229
    v_cvt_pk_bf16_f32 v150, v228, v229
    v_exp_f32 v230, v126
    s_waitcnt lgkmcnt(0)
    v_mfma_f32_32x32x16_bf16 v[48:63], v[220:223], v[156:159], v[48:63]
    v_add_f32 v233, v233, v230
    v_exp_f32 v231, v127
    s_nop 0
    v_add_f32 v233, v233, v231
    v_cvt_pk_bf16_f32 v151, v230, v231
    v_cmp_ngt_f32 vcc, s63, v233
    s_cbranch_vccnz L_fb13
L_ret13:
    v_add_f32 v232, v232, v233
    s_waitcnt vmcnt(8)
    s_barrier
    ds_read_b64_tr_b16 v[192:193], v235 offset:17408
    ds_read_b64_tr_b16 v[194:195], v235 offset:17664
    ds_read_b64_tr_b16 v[196:197], v235 offset:17472
    ds_read_b64_tr_b16 v[198:199], v235 offset:17728
    ds_read_b64_tr_b16 v[200:201], v235 offset:17536
    ds_read_b64_tr_b16 v[202:203], v235 offset:17792
    ds_read_b64_tr_b16 v[204:205], v235 offset:17600
    ds_read_b64_tr_b16 v[206:207], v235 offset:17856
    ds_read_b64_tr_b16 v[208:209], v235 offset:17920
    ds_read_b64_tr_b16 v[210:211], v235 offset:18176
    ds_read_b64_tr_b16 v[212:213], v235 offset:17984
    ds_read_b64_tr_b16 v[214:215], v235 offset:18240
    ds_read_b64_tr_b16 v[216:217], v235 offset:18048
    ds_read_b64_tr_b16 v[218:219], v235 offset:18304
    ds_read_b64_tr_b16 v[220:221], v235 offset:18112
    ds_read_b64_tr_b16 v[222:223], v235 offset:18368
    s_waitcnt lgkmcnt(14)
    v_mfma_f32_32x32x16_bf16 v[0:15], v[192:195], v[144:147], v[0:15]
    v_exp_f32 v224, v128
    v_exp_f32 v225, v129
    s_add_u32 m0, s66, 20480
    s_waitcnt lgkmcnt(12)
    v_mfma_f32_32x32x16_bf16 v[16:31], v[196:199], v[144:147], v[16:31]
    buffer_load_dwordx4 v251, s[36:39], s58 offen lds
    v_add_f32 v233, v224, v225
    v_cvt_pk_bf16_f32 v152, v224, v225
    v_exp_f32 v226, v130
    s_nop 0
    v_add_f32 v233, v233, v226
    v_exp_f32 v227, v131
    s_add_u32 m0, s66, 21504
    s_waitcnt lgkmcnt(10)
    v_mfma_f32_32x32x16_bf16 v[32:47], v[200:203], v[144:147], v[32:47]
    buffer_load_dwordx4 v252, s[36:39], s58 offen lds
    v_add_f32 v233, v233, v227
    v_cvt_pk_bf16_f32 v153, v226, v227
    v_exp_f32 v228, v132
    s_nop 0
    v_add_f32 v233, v233, v228
    v_exp_f32 v229, v133
    s_add_u32 m0, s66, 22528
    s_waitcnt lgkmcnt(8)
    v_mfma_f32_32x32x16_bf16 v[48:63], v[204:207], v[144:147], v[48:63]
    buffer_load_dwordx4 v253, s[36:39], s58 offen lds
    v_add_f32 v233, v233, v229
    v_cvt_pk_bf16_f32 v154, v228, v229
    v_exp_f32 v230, v134
    s_nop 0
    v_add_f32 v233, v233, v230
    v_exp_f32 v231, v135
    s_add_u32 m0, s66, 23552
    s_waitcnt lgkmcnt(6)
    v_mfma_f32_32x32x16_bf16 v[0:15], v[208:211], v[148:151], v[0:15]
    buffer_load_dwordx4 v254, s[36:39], s58 offen lds
    v_add_f32 v233, v233, v231
    v_cvt_pk_bf16_f32 v155, v230, v231
    v_exp_f32 v224, v136
    s_nop 0
    v_add_f32 v233, v233, v224
    v_exp_f32 v225, v137
    s_add_u32 m0, s66, 24576
    s_waitcnt lgkmcnt(4)
    v_mfma_f32_32x32x16_bf16 v[16:31], v[212:215], v[148:151], v[16:31]
    buffer_load_dwordx4 v255, s[36:39], s58 offen lds
    v_add_f32 v233, v233, v225
    v_cvt_pk_bf16_f32 v156, v224, v225
    v_exp_f32 v226, v138
    s_nop 0
    v_add_f32 v233, v233, v226
    v_exp_f32 v227, v139
    s_waitcnt lgkmcnt(2)
    v_mfma_f32_32x32x16_bf16 v[32:47], v[216:219], v[148:151], v[32:47]
    v_add_f32 v233, v233, v227
    v_cvt_pk_bf16_f32 v157, v226, v227
    v_exp_f32 v228, v140
    s_nop 0
    v_add_f32 v233, v233, v228
    v_exp_f32 v229, v141
    s_waitcnt lgkmcnt(0)
    v_mfma_f32_32x32x16_bf16 v[48:63], v[220:223], v[148:151], v[48:63]
    v_add_f32 v233, v233, v229
    v_cvt_pk_bf16_f32 v158, v228, v229
    v_exp_f32 v230, v142
    s_nop 0
    v_add_f32 v233, v233, v230
    v_exp_f32 v231, v143
    s_nop 0
    v_add_f32 v233, v233, v231
    v_cvt_pk_bf16_f32 v159, v230, v231
    v_cmp_ngt_f32 vcc, s63, v233
    s_cbranch_vccnz L_fb14
L_ret14:
    v_add_f32 v232, v232, v233
    s_waitcnt vmcnt(10)
    s_barrier
    ds_read_b64_tr_b16 v[192:193], v235 offset:26112
    ds_read_b64_tr_b16 v[194:195], v235 offset:26368
    ds_read_b64_tr_b16 v[208:209], v235 offset:26624
    ds_read_b64_tr_b16 v[210:211], v235 offset:26880
    ds_read_b64_tr_b16 v[196:197], v235 offset:26176
    ds_read_b64_tr_b16 v[198:199], v235 offset:26432
    ds_read_b64_tr_b16 v[212:213], v235 offset:26688
    ds_read_b64_tr_b16 v[214:215], v235 offset:26944
    ds_read_b64_tr_b16 v[200:201], v235 offset:26240
    ds_read_b64_tr_b16 v[202:203], v235 offset:26496
    ds_read_b64_tr_b16 v[216:217], v235 offset:26752
    ds_read_b64_tr_b16 v[218:219], v235 offset:27008
    ds_read_b64_tr_b16 v[204:205], v235 offset:26304
    ds_read_b64_tr_b16 v[206:207], v235 offset:26560
    ds_read_b64_tr_b16 v[220:221], v235 offset:26816
    ds_read_b64_tr_b16 v[222:223], v235 offset:27072
    s_waitcnt lgkmcnt(14)
    v_mfma_f32_32x32x16_bf16 v[0:15], v[192:195], v[152:155], v[0:15]
    v_mov_b32 v245, v232
    s_nop 1
    v_permlane32_swap_b32 v232, v245
    v_add_f32 v232, v232, v245
    v_rcp_f32 v232, v232
    s_lshl_b32 s59, s49, 5
    s_add_u32 s59, s59, s50
    s_lshl_b32 s59, s59, 2
    s_add_u32 s59, s59, s96
    s_lshl_b32 s59, s59, 13
    s_add_u32 s60, s59, 4096
    v_mov_b32 v144, s100
    s_lshl_b32 s45, s49, 2
    s_add_u32 s45, s45, s98
    s_lshl_b32 s45, s45, 3
    s_add_u32 s45, s45, s48
    s_lshl_b32 s45, s45, 7
    s_add_u32 s45, s45, 41943040
    s_lshl_b32 s10, s99, 2
    s_add_u32 s10, s10, s45
    s_lshl_b32 s51, s96, 13
    s_add_u32 s51, s51, 122880
    v_add_u32 v244, s51, v248
    s_waitcnt lgkmcnt(12)
    v_mfma_f32_32x32x16_bf16 v[0:15], v[208:211], v[156:159], v[0:15]
    s_waitcnt lgkmcnt(10)
    v_mfma_f32_32x32x16_bf16 v[16:31], v[196:199], v[152:155], v[16:31]
    s_waitcnt vmcnt(0) lgkmcnt(0)
    s_barrier
    v_mfma_f32_32x32x16_bf16 v[16:31], v[212:215], v[156:159], v[16:31]
    s_nop 6
    v_mul_f32 v0, v232, v0
    v_mul_f32 v1, v232, v1
    v_mul_f32 v2, v232, v2
    v_mul_f32 v3, v232, v3
    v_mul_f32 v4, v232, v4
    v_mul_f32 v5, v232, v5
    v_mul_f32 v6, v232, v6
    v_mul_f32 v7, v232, v7
    v_cvt_pk_bf16_f32 v160, v0, v1
    v_cvt_pk_bf16_f32 v161, v2, v3
    v_cvt_pk_bf16_f32 v162, v4, v5
    v_cvt_pk_bf16_f32 v163, v6, v7
    buffer_store_dwordx4 v[160:163], v248, s[40:43], s59 offen offset:0 sc1
    v_mul_f32 v8, v232, v8
    v_mul_f32 v9, v232, v9
    v_mul_f32 v10, v232, v10
    v_mul_f32 v11, v232, v11
    v_mul_f32 v12, v232, v12
    v_mul_f32 v13, v232, v13
    v_mul_f32 v14, v232, v14
    v_mul_f32 v15, v232, v15
    v_cvt_pk_bf16_f32 v164, v8, v9
    v_cvt_pk_bf16_f32 v165, v10, v11
    v_cvt_pk_bf16_f32 v166, v12, v13
    v_cvt_pk_bf16_f32 v167, v14, v15
    buffer_store_dwordx4 v[164:167], v248, s[40:43], s59 offen offset:1024 sc1
    v_mfma_f32_32x32x16_bf16 v[32:47], v[200:203], v[152:155], v[32:47]
    v_mfma_f32_32x32x16_bf16 v[32:47], v[216:219], v[156:159], v[32:47]
    v_mul_f32 v16, v232, v16
    v_mul_f32 v17, v232, v17
    v_mul_f32 v18, v232, v18
    v_mul_f32 v19, v232, v19
    v_mul_f32 v20, v232, v20
    v_mul_f32 v21, v232, v21
    v_mul_f32 v22, v232, v22
    v_mul_f32 v23, v232, v23
    v_cvt_pk_bf16_f32 v168, v16, v17
    v_cvt_pk_bf16_f32 v169, v18, v19
    v_cvt_pk_bf16_f32 v170, v20, v21
    v_cvt_pk_bf16_f32 v171, v22, v23
    buffer_store_dwordx4 v[168:171], v248, s[40:43], s59 offen offset:2048 sc1
    v_mul_f32 v24, v232, v24
    v_mul_f32 v25, v232, v25
    v_mul_f32 v26, v232, v26
    v_mul_f32 v27, v232, v27
    v_mul_f32 v28, v232, v28
    v_mul_f32 v29, v232, v29
    v_mul_f32 v30, v232, v30
    v_mul_f32 v31, v232, v31
    v_cvt_pk_bf16_f32 v172, v24, v25
    v_cvt_pk_bf16_f32 v173, v26, v27
    v_cvt_pk_bf16_f32 v174, v28, v29
    v_cvt_pk_bf16_f32 v175, v30, v31
    buffer_store_dwordx4 v[172:175], v248, s[40:43], s59 offen offset:3072 sc1
    v_mfma_f32_32x32x16_bf16 v[48:63], v[204:207], v[152:155], v[48:63]
    v_mfma_f32_32x32x16_bf16 v[48:63], v[220:223], v[156:159], v[48:63]
    v_mul_f32 v32, v232, v32
    v_mul_f32 v33, v232, v33
    v_mul_f32 v34, v232, v34
    v_mul_f32 v35, v232, v35
    v_mul_f32 v36, v232, v36
    v_mul_f32 v37, v232, v37
    v_mul_f32 v38, v232, v38
    v_mul_f32 v39, v232, v39
    v_cvt_pk_bf16_f32 v176, v32, v33
    v_cvt_pk_bf16_f32 v177, v34, v35
    v_cvt_pk_bf16_f32 v178, v36, v37
    v_cvt_pk_bf16_f32 v179, v38, v39
    buffer_store_dwordx4 v[176:179], v248, s[40:43], s60 offen offset:0 sc1
    v_mul_f32 v40, v232, v40
    v_mul_f32 v41, v232, v41
    v_mul_f32 v42, v232, v42
    v_mul_f32 v43, v232, v43
    v_mul_f32 v44, v232, v44
    v_mul_f32 v45, v232, v45
    v_mul_f32 v46, v232, v46
    v_mul_f32 v47, v232, v47
    v_cvt_pk_bf16_f32 v180, v40, v41
    v_cvt_pk_bf16_f32 v181, v42, v43
    v_cvt_pk_bf16_f32 v182, v44, v45
    v_cvt_pk_bf16_f32 v183, v46, v47
    buffer_store_dwordx4 v[180:183], v248, s[40:43], s60 offen offset:1024 sc1
    v_mul_f32 v48, v232, v48
    v_mul_f32 v49, v232, v49
    v_mul_f32 v50, v232, v50
    v_mul_f32 v51, v232, v51
    v_mul_f32 v52, v232, v52
    v_mul_f32 v53, v232, v53
    v_mul_f32 v54, v232, v54
    v_mul_f32 v55, v232, v55
    v_cvt_pk_bf16_f32 v184, v48, v49
    v_cvt_pk_bf16_f32 v185, v50, v51
    v_cvt_pk_bf16_f32 v186, v52, v53
    v_cvt_pk_bf16_f32 v187, v54, v55
    buffer_store_dwordx4 v[184:187], v248, s[40:43], s60 offen offset:2048 sc1
    v_mul_f32 v56, v232, v56
    v_mul_f32 v57, v232, v57
    v_mul_f32 v58, v232, v58
    v_mul_f32 v59, v232, v59
    v_mul_f32 v60, v232, v60
    v_mul_f32 v61, v232, v61
    v_mul_f32 v62, v232, v62
    v_mul_f32 v63, v232, v63
    v_cvt_pk_bf16_f32 v188, v56, v57
    v_cvt_pk_bf16_f32 v189, v58, v59
    v_cvt_pk_bf16_f32 v190, v60, v61
    v_cvt_pk_bf16_f32 v191, v62, v63
    buffer_store_dwordx4 v[188:191], v248, s[40:43], s60 offen offset:3072 sc1
    s_cmp_eq_u32 s97, 0
    s_cbranch_scc1 L_g0t
    ds_write_b128 v244, v[160:163] offset:0
    ds_write_b128 v244, v[164:167] offset:1024
    ds_write_b128 v244, v[168:171] offset:2048
    ds_write_b128 v244, v[172:175] offset:3072
    ds_write_b128 v244, v[176:179] offset:4096
    ds_write_b128 v244, v[180:183] offset:5120
    ds_write_b128 v244, v[184:187] offset:6144
    ds_write_b128 v244, v[188:191] offset:7168
    s_waitcnt lgkmcnt(0)
    s_barrier
    s_add_u32 s51, s99, 1
    s_and_b32 s51, s51, 3
    s_lshl_b32 s51, s51, 1
    s_add_u32 s51, s51, 1
    s_xor_b32 s51, s51, s68
    s_mul_i32 s51, s51, 163840
    s_add_u32 s57, s51, s65
    s_add_u32 s58, s57, 81920
    s_add_u32 m0, s66, -81920
    s_nop 0
    buffer_load_dwordx4 v251, s[36:39], s57 offen lds
    s_add_u32 m0, s66, -80896
    s_nop 0
    buffer_load_dwordx4 v252, s[36:39], s57 offen lds
    s_add_u32 m0, s66, -79872
    s_nop 0
    buffer_load_dwordx4 v253, s[36:39], s57 offen lds
    s_add_u32 m0, s66, -78848
    s_nop 0
    buffer_load_dwordx4 v254, s[36:39], s57 offen lds
    s_add_u32 m0, s66, -77824
    s_nop 0
    buffer_load_dwordx4 v255, s[36:39], s57 offen lds
    s_add_u32 m0, s66, -61440
    s_nop 0
    buffer_load_dwordx4 v251, s[36:39], s58 offen lds
    s_add_u32 m0, s66, -60416
    s_nop 0
    buffer_load_dwordx4 v252, s[36:39], s58 offen lds
    s_add_u32 m0, s66, -59392
    s_nop 0
    buffer_load_dwordx4 v253, s[36:39], s58 offen lds
    s_add_u32 m0, s66, -58368
    s_nop 0
    buffer_load_dwordx4 v254, s[36:39], s58 offen lds
    s_add_u32 m0, s66, -57344
    s_nop 0
    buffer_load_dwordx4 v255, s[36:39], s58 offen lds
    s_barrier
    s_add_u32 s51, s99, 2
    s_and_b32 s51, s51, 3
    s_lshl_b32 s51, s51, 1
    s_add_u32 s51, s51, 1
    s_xor_b32 s51, s51, s68
    s_mul_i32 s51, s51, 163840
    s_add_u32 s57, s51, s65
    s_add_u32 s58, s57, 81920
    s_add_u32 m0, s66, 40960
    s_nop 0
    buffer_load_dwordx4 v251, s[36:39], s57 offen lds
    s_add_u32 m0, s66, 41984
    s_nop 0
    buffer_load_dwordx4 v252, s[36:39], s57 offen lds
    s_add_u32 m0, s66, 43008
    s_nop 0
    buffer_load_dwordx4 v253, s[36:39], s57 offen lds
    s_add_u32 m0, s66, 44032
    s_nop 0
    buffer_load_dwordx4 v254, s[36:39], s57 offen lds
    s_add_u32 m0, s66, 45056
    s_nop 0
    buffer_load_dwordx4 v255, s[36:39], s57 offen lds
    s_add_u32 m0, s66, 61440
    s_nop 0
    buffer_load_dwordx4 v251, s[36:39], s58 offen lds
    s_add_u32 m0, s66, 62464
    s_nop 0
    buffer_load_dwordx4 v252, s[36:39], s58 offen lds
    s_add_u32 m0, s66, 63488
    s_nop 0
    buffer_load_dwordx4 v253, s[36:39], s58 offen lds
    s_add_u32 m0, s66, 64512
    s_nop 0
    buffer_load_dwordx4 v254, s[36:39], s58 offen lds
    s_add_u32 m0, s66, 65536
    s_nop 0
    buffer_load_dwordx4 v255, s[36:39], s58 offen lds
    s_waitcnt vmcnt(20)
    s_mov_b64 exec, 1
    buffer_store_dword v144, off, s[40:43], s10 sc1
    s_mov_b64 exec, -1
    s_waitcnt vmcnt(1)
    s_barrier
    s_add_u32 s51, s99, 3
    s_and_b32 s51, s51, 3
    s_lshl_b32 s51, s51, 1
    s_add_u32 s51, s51, 1
    s_xor_b32 s51, s51, s68
    s_mul_i32 s51, s51, 163840
    s_add_u32 s57, s51, s65
    s_add_u32 s58, s57, 81920
    s_add_u32 m0, s66, -40960
    s_nop 0
    buffer_load_dwordx4 v251, s[36:39], s57 offen lds
    s_add_u32 m0, s66, -39936
    s_nop 0
    buffer_load_dwordx4 v252, s[36:39], s57 offen lds
    s_add_u32 m0, s66, -38912
    s_nop 0
    buffer_load_dwordx4 v253, s[36:39], s57 offen lds
    s_add_u32 m0, s66, -37888
    s_nop 0
    buffer_load_dwordx4 v254, s[36:39], s57 offen lds
    s_add_u32 m0, s66, -36864
    s_nop 0
    buffer_load_dwordx4 v255, s[36:39], s57 offen lds
    s_add_u32 m0, s66, -20480
    s_nop 0
    buffer_load_dwordx4 v251, s[36:39], s58 offen lds
    s_add_u32 m0, s66, -19456
    s_nop 0
    buffer_load_dwordx4 v252, s[36:39], s58 offen lds
    s_add_u32 m0, s66, -18432
    s_nop 0
    buffer_load_dwordx4 v253, s[36:39], s58 offen lds
    s_add_u32 m0, s66, -17408
    s_nop 0
    buffer_load_dwordx4 v254, s[36:39], s58 offen lds
    s_add_u32 m0, s66, -16384
    s_nop 0
    buffer_load_dwordx4 v255, s[36:39], s58 offen lds
    s_waitcnt vmcnt(0)
    s_barrier
    s_endpgm
L_g0t:
    v_add_u32 v238, 40960, v249
    v_add_u32 v234, 81920, v249
    v_add_u32 v235, 122880, v249
    v_add_u32 v233, s99, v243
    v_and_b32 v233, 3, v233
    v_lshlrev_b32 v233, 2, v233
    v_sub_u32 v237, s98, v243
    v_and_b32 v237, 3, v237
    v_lshlrev_b32 v237, 2, v237
    s_barrier
    ds_read_b64_tr_b16 v[192:193], v249 offset:0
    ds_read_b64_tr_b16 v[194:195], v249 offset:1280
    ds_read_b64_tr_b16 v[196:197], v249 offset:8
    ds_read_b64_tr_b16 v[198:199], v249 offset:1288
    ds_read_b64_tr_b16 v[200:201], v249 offset:16
    ds_read_b64_tr_b16 v[202:203], v249 offset:1296
    ds_read_b64_tr_b16 v[204:205], v249 offset:24
    ds_read_b64_tr_b16 v[206:207], v249 offset:1304
    ds_read_b64_tr_b16 v[208:209], v249 offset:32
    ds_read_b64_tr_b16 v[210:211], v249 offset:1312
    s_add_u32 m0, s66, 40960
    s_waitcnt lgkmcnt(8)
    v_mfma_f32_32x32x16_bf16 v[0:15], v[192:195], v[160:163], 0
    ds_read_b64_tr_b16 v[212:213], v249 offset:5120
    ds_read_b64_tr_b16 v[214:215], v249 offset:6400
    ds_read_b64_tr_b16 v[216:217], v249 offset:5128
    s_add_u32 s51, s99, 1
    s_and_b32 s51, s51, 3
    s_lshl_b32 s51, s51, 1
    s_xor_b32 s51, s51, s68
    s_mul_i32 s51, s51, 163840
    s_add_u32 s57, s51, s65
    buffer_load_dwordx4 v251, s[36:39], s57 offen lds
    s_waitcnt lgkmcnt(9)
    v_mfma_f32_32x32x16_bf16 v[16:31], v[196:199], v[160:163], 0
    ds_read_b64_tr_b16 v[218:219], v249 offset:6408
    ds_read_b64_tr_b16 v[220:221], v249 offset:5136
    ds_read_b64_tr_b16 v[222:223], v249 offset:6416
    s_add_u32 m0, s66, 41984
    s_waitcnt lgkmcnt(10)
    v_mfma_f32_32x32x16_bf16 v[32:47], v[200:203], v[160:163], 0
    ds_read_b64_tr_b16 v[224:225], v249 offset:5144
    ds_read_b64_tr_b16 v[226:227], v249 offset:6424
    ds_read_b64_tr_b16 v[228:229], v249 offset:5152
    buffer_load_dwordx4 v252, s[36:39], s57 offen lds
    s_waitcnt lgkmcnt(11)
    v_mfma_f32_32x32x16_bf16 v[48:63], v[204:207], v[160:163], 0
    ds_read_b64_tr_b16 v[230:231], v249 offset:6432
    s_add_u32 m0, s66, 43008
    s_waitcnt lgkmcnt(10)
    v_mfma_f32_32x32x16_bf16 v[64:79], v[208:211], v[160:163], 0
    buffer_load_dwordx4 v253, s[36:39], s57 offen lds
    s_waitcnt vmcnt(3)
    s_mov_b64 exec, 1
    buffer_store_dword v144, off, s[40:43], s10 sc1
    s_mov_b64 exec, -1
    s_waitcnt lgkmcnt(8)
    v_mfma_f32_32x32x16_bf16 v[0:15], v[212:215], v[164:167], v[0:15]
    ds_read_b64_tr_b16 v[192:193], v249 offset:10240
    ds_read_b64_tr_b16 v[194:195], v249 offset:11520
    ds_read_b64_tr_b16 v[196:197], v249 offset:10248
    s_add_u32 m0, s66, 44032
    s_waitcnt lgkmcnt(9)
    v_mfma_f32_32x32x16_bf16 v[16:31], v[216:219], v[164:167], v[16:31]
    ds_read_b64_tr_b16 v[198:199], v249 offset:11528
    ds_read_b64_tr_b16 v[200:201], v249 offset:10256
    ds_read_b64_tr_b16 v[202:203], v249 offset:11536
    buffer_load_dwordx4 v254, s[36:39], s57 offen lds
    s_waitcnt lgkmcnt(10)
    v_mfma_f32_32x32x16_bf16 v[32:47], v[220:223], v[164:167], v[32:47]
    ds_read_b64_tr_b16 v[204:205], v249 offset:10264
    ds_read_b64_tr_b16 v[206:207], v249 offset:11544
    ds_read_b64_tr_b16 v[208:209], v249 offset:10272
    s_add_u32 m0, s66, 45056
    s_waitcnt lgkmcnt(11)
    v_mfma_f32_32x32x16_bf16 v[48:63], v[224:227], v[164:167], v[48:63]
    ds_read_b64_tr_b16 v[210:211], v249 offset:11552
    buffer_load_dwordx4 v255, s[36:39], s57 offen lds
    s_waitcnt lgkmcnt(10)
    v_mfma_f32_32x32x16_bf16 v[64:79], v[228:231], v[164:167], v[64:79]
    s_barrier
    s_add_u32 m0, s66, 61440
    s_waitcnt lgkmcnt(8)
    v_mfma_f32_32x32x16_bf16 v[0:15], v[192:195], v[168:171], v[0:15]
    ds_read_b64_tr_b16 v[212:213], v249 offset:15360
    ds_read_b64_tr_b16 v[214:215], v249 offset:16640
    ds_read_b64_tr_b16 v[216:217], v249 offset:15368
    s_add_u32 s51, s99, 1
    s_and_b32 s51, s51, 3
    s_lshl_b32 s51, s51, 1
    s_xor_b32 s51, s51, s68
    s_mul_i32 s51, s51, 163840
    s_add_u32 s57, s51, s65
    s_add_u32 s58, s57, 81920
    buffer_load_dwordx4 v251, s[36:39], s58 offen lds
    s_waitcnt lgkmcnt(9)
    v_mfma_f32_32x32x16_bf16 v[16:31], v[196:199], v[168:171], v[16:31]
    ds_read_b64_tr_b16 v[218:219], v249 offset:16648
    ds_read_b64_tr_b16 v[220:221], v249 offset:15376
    ds_read_b64_tr_b16 v[222:223], v249 offset:16656
    s_add_u32 m0, s66, 62464
    s_waitcnt lgkmcnt(10)
    v_mfma_f32_32x32x16_bf16 v[32:47], v[200:203], v[168:171], v[32:47]
    ds_read_b64_tr_b16 v[224:225], v249 offset:15384
    ds_read_b64_tr_b16 v[226:227], v249 offset:16664
    ds_read_b64_tr_b16 v[228:229], v249 offset:15392
    buffer_load_dwordx4 v252, s[36:39], s58 offen lds
    s_waitcnt lgkmcnt(11)
    v_mfma_f32_32x32x16_bf16 v[48:63], v[204:207], v[168:171], v[48:63]
    ds_read_b64_tr_b16 v[230:231], v249 offset:16672
    s_add_u32 m0, s66, 63488
    s_waitcnt lgkmcnt(10)
    v_mfma_f32_32x32x16_bf16 v[64:79], v[208:211], v[168:171], v[64:79]
    buffer_load_dwordx4 v253, s[36:39], s58 offen lds
    s_waitcnt lgkmcnt(8)
    v_mfma_f32_32x32x16_bf16 v[0:15], v[212:215], v[172:175], v[0:15]
    ds_read_b64_tr_b16 v[192:193], v249 offset:20480
    ds_read_b64_tr_b16 v[194:195], v249 offset:21760
    ds_read_b64_tr_b16 v[196:197], v249 offset:20488
    s_add_u32 m0, s66, 64512
    s_waitcnt lgkmcnt(9)
    v_mfma_f32_32x32x16_bf16 v[16:31], v[216:219], v[172:175], v[16:31]
    ds_read_b64_tr_b16 v[198:199], v249 offset:21768
    ds_read_b64_tr_b16 v[200:201], v249 offset:20496
    ds_read_b64_tr_b16 v[202:203], v249 offset:21776
    buffer_load_dwordx4 v254, s[36:39], s58 offen lds
    s_waitcnt lgkmcnt(10)
    v_mfma_f32_32x32x16_bf16 v[32:47], v[220:223], v[172:175], v[32:47]
    ds_read_b64_tr_b16 v[204:205], v249 offset:20504
    ds_read_b64_tr_b16 v[206:207], v249 offset:21784
    ds_read_b64_tr_b16 v[208:209], v249 offset:20512
    s_add_u32 m0, s66, 65536
    s_waitcnt lgkmcnt(11)
    v_mfma_f32_32x32x16_bf16 v[48:63], v[224:227], v[172:175], v[48:63]
    ds_read_b64_tr_b16 v[210:211], v249 offset:21792
    buffer_load_dwordx4 v255, s[36:39], s58 offen lds
    s_waitcnt lgkmcnt(10)
    v_mfma_f32_32x32x16_bf16 v[64:79], v[228:231], v[172:175], v[64:79]
    s_barrier
    s_add_u32 m0, s66, 0
    s_waitcnt lgkmcnt(8)
    v_mfma_f32_32x32x16_bf16 v[0:15], v[192:195], v[176:179], v[0:15]
    ds_read_b64_tr_b16 v[212:213], v249 offset:25600
    ds_read_b64_tr_b16 v[214:215], v249 offset:26880
    ds_read_b64_tr_b16 v[216:217], v249 offset:25608
    s_add_u32 s51, s99, 2
    s_and_b32 s51, s51, 3
    s_lshl_b32 s51, s51, 1
    s_xor_b32 s51, s51, s68
    s_mul_i32 s51, s51, 163840
    s_add_u32 s57, s51, s65
    buffer_load_dwordx4 v251, s[36:39], s57 offen lds
    s_waitcnt lgkmcnt(9)
    v_mfma_f32_32x32x16_bf16 v[16:31], v[196:199], v[176:179], v[16:31]
    ds_read_b64_tr_b16 v[218:219], v249 offset:26888
    ds_read_b64_tr_b16 v[220:221], v249 offset:25616
    ds_read_b64_tr_b16 v[222:223], v249 offset:26896
    s_add_u32 m0, s66, 1024
    s_waitcnt lgkmcnt(10)
    v_mfma_f32_32x32x16_bf16 v[32:47], v[200:203], v[176:179], v[32:47]
    ds_read_b64_tr_b16 v[224:225], v249 offset:25624
    ds_read_b64_tr_b16 v[226:227], v249 offset:26904
    ds_read_b64_tr_b16 v[228:229], v249 offset:25632
    buffer_load_dwordx4 v252, s[36:39], s57 offen lds
    s_waitcnt lgkmcnt(11)
    v_mfma_f32_32x32x16_bf16 v[48:63], v[204:207], v[176:179], v[48:63]
    ds_read_b64_tr_b16 v[230:231], v249 offset:26912
    s_add_u32 m0, s66, 2048
    s_waitcnt lgkmcnt(10)
    v_mfma_f32_32x32x16_bf16 v[64:79], v[208:211], v[176:179], v[64:79]
    buffer_load_dwordx4 v253, s[36:39], s57 offen lds
    s_waitcnt lgkmcnt(8)
    v_mfma_f32_32x32x16_bf16 v[0:15], v[212:215], v[180:183], v[0:15]
    ds_read_b64_tr_b16 v[192:193], v249 offset:30720
    ds_read_b64_tr_b16 v[194:195], v249 offset:32000
    ds_read_b64_tr_b16 v[196:197], v249 offset:30728
    s_add_u32 m0, s66, 3072
    s_waitcnt lgkmcnt(9)
    v_mfma_f32_32x32x16_bf16 v[16:31], v[216:219], v[180:183], v[16:31]
    ds_read_b64_tr_b16 v[198:199], v249 offset:32008
    ds_read_b64_tr_b16 v[200:201], v249 offset:30736
    ds_read_b64_tr_b16 v[202:203], v249 offset:32016
    buffer_load_dwordx4 v254, s[36:39], s57 offen lds
    s_waitcnt lgkmcnt(10)
    v_mfma_f32_32x32x16_bf16 v[32:47], v[220:223], v[180:183], v[32:47]
    ds_read_b64_tr_b16 v[204:205], v249 offset:30744
    ds_read_b64_tr_b16 v[206:207], v249 offset:32024
    ds_read_b64_tr_b16 v[208:209], v249 offset:30752
    s_add_u32 m0, s66, 4096
    s_waitcnt lgkmcnt(11)
    v_mfma_f32_32x32x16_bf16 v[48:63], v[224:227], v[180:183], v[48:63]
    ds_read_b64_tr_b16 v[210:211], v249 offset:32032
    buffer_load_dwordx4 v255, s[36:39], s57 offen lds
    s_waitcnt lgkmcnt(10)
    v_mfma_f32_32x32x16_bf16 v[64:79], v[228:231], v[180:183], v[64:79]
    s_waitcnt vmcnt(10)
    s_barrier
    s_waitcnt lgkmcnt(8)
    v_mfma_f32_32x32x16_bf16 v[0:15], v[192:195], v[184:187], v[0:15]
    ds_read_b64_tr_b16 v[212:213], v249 offset:35840
    ds_read_b64_tr_b16 v[214:215], v249 offset:37120
    ds_read_b64_tr_b16 v[216:217], v249 offset:35848
    s_waitcnt lgkmcnt(9)
    v_mfma_f32_32x32x16_bf16 v[16:31], v[196:199], v[184:187], v[16:31]
    ds_read_b64_tr_b16 v[218:219], v249 offset:37128
    ds_read_b64_tr_b16 v[220:221], v249 offset:35856
    ds_read_b64_tr_b16 v[222:223], v249 offset:37136
    s_waitcnt lgkmcnt(10)
    v_mfma_f32_32x32x16_bf16 v[32:47], v[200:203], v[184:187], v[32:47]
    ds_read_b64_tr_b16 v[224:225], v249 offset:35864
    ds_read_b64_tr_b16 v[226:227], v249 offset:37144
    ds_read_b64_tr_b16 v[228:229], v249 offset:35872
    s_waitcnt lgkmcnt(11)
    v_mfma_f32_32x32x16_bf16 v[48:63], v[204:207], v[184:187], v[48:63]
    ds_read_b64_tr_b16 v[230:231], v249 offset:37152
    s_waitcnt lgkmcnt(10)
    v_mfma_f32_32x32x16_bf16 v[64:79], v[208:211], v[184:187], v[64:79]
    s_waitcnt lgkmcnt(8)
    v_mfma_f32_32x32x16_bf16 v[0:15], v[212:215], v[188:191], v[0:15]
    ds_read_b64_tr_b16 v[192:193], v250 offset:0
    ds_read_b64_tr_b16 v[194:195], v250 offset:1280
    ds_read_b64_tr_b16 v[196:197], v250 offset:8
    s_waitcnt lgkmcnt(9)
    v_mfma_f32_32x32x16_bf16 v[16:31], v[216:219], v[188:191], v[16:31]
    ds_read_b64_tr_b16 v[198:199], v250 offset:1288
    ds_read_b64_tr_b16 v[200:201], v250 offset:16
    ds_read_b64_tr_b16 v[202:203], v250 offset:1296
    s_waitcnt lgkmcnt(10)
    v_mfma_f32_32x32x16_bf16 v[32:47], v[220:223], v[188:191], v[32:47]
    ds_read_b64_tr_b16 v[204:205], v250 offset:24
    ds_read_b64_tr_b16 v[206:207], v250 offset:1304
    ds_read_b64_tr_b16 v[208:209], v250 offset:32
    s_waitcnt lgkmcnt(11)
    v_mfma_f32_32x32x16_bf16 v[48:63], v[224:227], v[188:191], v[48:63]
    ds_read_b64_tr_b16 v[210:211], v250 offset:1312
    s_waitcnt lgkmcnt(10)
    v_mfma_f32_32x32x16_bf16 v[64:79], v[228:231], v[188:191], v[64:79]
    buffer_load_dword v145, v233, s[40:43], s45 offen sc1
    s_barrier
    s_waitcnt vmcnt(0)
    v_readlane_b32 s51, v145, 1
    s_nop 0
    s_cmp_lg_u32 s51, s100
    s_cbranch_scc1 L_rt_e1
L_ok_e1:
    s_add_u32 s51, s99, 1
    s_and_b32 s51, s51, 3
    s_sub_u32 s51, s51, s99
    s_lshl_b32 s51, s51, 16
    s_add_u32 s52, s51, s59
    s_add_u32 s53, s51, s60
    buffer_load_dwordx4 v[80:83], v248, s[40:43], s52 offen offset:0 sc1
    buffer_load_dwordx4 v[84:87], v248, s[40:43], s52 offen offset:1024 sc1
    buffer_load_dwordx4 v[88:91], v248, s[40:43], s52 offen offset:2048 sc1
    buffer_load_dwordx4 v[92:95], v248, s[40:43], s52 offen offset:3072 sc1
    buffer_load_dwordx4 v[96:99], v248, s[40:43], s53 offen offset:0 sc1
    buffer_load_dwordx4 v[100:103], v248, s[40:43], s53 offen offset:1024 sc1
    buffer_load_dwordx4 v[104:107], v248, s[40:43], s53 offen offset:2048 sc1
    buffer_load_dwordx4 v[108:111], v248, s[40:43], s53 offen offset:3072 sc1
    s_add_u32 s51, s99, 2
    s_and_b32 s51, s51, 3
    s_lshl_b32 s51, s51, 1
    s_xor_b32 s51, s51, s68
    s_mul_i32 s51, s51, 163840
    s_add_u32 s57, s51, s65
    s_add_u32 s58, s57, 81920
    s_add_u32 m0, s66, 20480
    s_nop 0
    buffer_load_dwordx4 v251, s[36:39], s58 offen lds
    s_add_u32 m0, s66, 21504
    s_nop 0
    buffer_load_dwordx4 v252, s[36:39], s58 offen lds
    s_add_u32 m0, s66, 22528
    s_nop 0
    buffer_load_dwordx4 v253, s[36:39], s58 offen lds
    s_add_u32 m0, s66, 23552
    s_nop 0
    buffer_load_dwordx4 v254, s[36:39], s58 offen lds
    s_add_u32 m0, s66, 24576
    s_nop 0
    buffer_load_dwordx4 v255, s[36:39], s58 offen lds
    s_barrier
    s_waitcnt vmcnt(12) lgkmcnt(8)
    v_mfma_f32_32x32x16_bf16 v[0:15], v[192:195], v[80:83], v[0:15]
    ds_read_b64_tr_b16 v[212:213], v250 offset:5120
    ds_read_b64_tr_b16 v[214:215], v250 offset:6400
    ds_read_b64_tr_b16 v[216:217], v250 offset:5128
    buffer_load_dword v145, v233, s[40:43], s45 offen sc1
    s_waitcnt lgkmcnt(9)
    v_mfma_f32_32x32x16_bf16 v[16:31], v[196:199], v[80:83], v[16:31]
    ds_read_b64_tr_b16 v[218:219], v250 offset:6408
    ds_read_b64_tr_b16 v[220:221], v250 offset:5136
    ds_read_b64_tr_b16 v[222:223], v250 offset:6416
    s_waitcnt lgkmcnt(10)
    v_mfma_f32_32x32x16_bf16 v[32:47], v[200:203], v[80:83], v[32:47]
    ds_read_b64_tr_b16 v[224:225], v250 offset:5144
    ds_read_b64_tr_b16 v[226:227], v250 offset:6424
    ds_read_b64_tr_b16 v[228:229], v250 offset:5152
    s_waitcnt lgkmcnt(11)
    v_mfma_f32_32x32x16_bf16 v[48:63], v[204:207], v[80:83], v[48:63]
    ds_read_b64_tr_b16 v[230:231], v250 offset:6432
    s_waitcnt lgkmcnt(10)
    v_mfma_f32_32x32x16_bf16 v[64:79], v[208:211], v[80:83], v[64:79]
    s_waitcnt vmcnt(12) lgkmcnt(8)
    v_mfma_f32_32x32x16_bf16 v[0:15], v[212:215], v[84:87], v[0:15]
    ds_read_b64_tr_b16 v[192:193], v250 offset:10240
    ds_read_b64_tr_b16 v[194:195], v250 offset:11520
    ds_read_b64_tr_b16 v[196:197], v250 offset:10248
    s_waitcnt lgkmcnt(9)
    v_mfma_f32_32x32x16_bf16 v[16:31], v[216:219], v[84:87], v[16:31]
    ds_read_b64_tr_b16 v[198:199], v250 offset:11528
    ds_read_b64_tr_b16 v[200:201], v250 offset:10256
    ds_read_b64_tr_b16 v[202:203], v250 offset:11536
    s_waitcnt lgkmcnt(10)
    v_mfma_f32_32x32x16_bf16 v[32:47], v[220:223], v[84:87], v[32:47]
    ds_read_b64_tr_b16 v[204:205], v250 offset:10264
    ds_read_b64_tr_b16 v[206:207], v250 offset:11544
    ds_read_b64_tr_b16 v[208:209], v250 offset:10272
    s_waitcnt lgkmcnt(11)
    v_mfma_f32_32x32x16_bf16 v[48:63], v[224:227], v[84:87], v[48:63]
    ds_read_b64_tr_b16 v[210:211], v250 offset:11552
    s_waitcnt lgkmcnt(10)
    v_mfma_f32_32x32x16_bf16 v[64:79], v[228:231], v[84:87], v[64:79]
    s_barrier
    s_waitcnt vmcnt(0)
    v_readlane_b32 s51, v145, 2
    s_nop 0
    s_cmp_lg_u32 s51, s100
    s_cbranch_scc1 L_rt_e2
L_ok_e2:
    s_waitcnt lgkmcnt(8)
    v_mfma_f32_32x32x16_bf16 v[0:15], v[192:195], v[88:91], v[0:15]
    ds_read_b64_tr_b16 v[212:213], v250 offset:15360
    ds_read_b64_tr_b16 v[214:215], v250 offset:16640
    ds_read_b64_tr_b16 v[216:217], v250 offset:15368
    buffer_load_dword v145, v233, s[40:43], s45 offen sc1
    s_add_u32 s51, s99, 2
    s_and_b32 s51, s51, 3
    s_sub_u32 s51, s51, s99
    s_lshl_b32 s51, s51, 16
    s_add_u32 s52, s51, s59
    s_add_u32 s53, s51, s60
    buffer_load_dwordx4 v[112:115], v248, s[40:43], s52 offen offset:0 sc1
    s_waitcnt lgkmcnt(9)
    v_mfma_f32_32x32x16_bf16 v[16:31], v[196:199], v[88:91], v[16:31]
    ds_read_b64_tr_b16 v[218:219], v250 offset:16648
    ds_read_b64_tr_b16 v[220:221], v250 offset:15376
    ds_read_b64_tr_b16 v[222:223], v250 offset:16656
    buffer_load_dwordx4 v[116:119], v248, s[40:43], s52 offen offset:1024 sc1
    s_waitcnt lgkmcnt(10)
    v_mfma_f32_32x32x16_bf16 v[32:47], v[200:203], v[88:91], v[32:47]
    ds_read_b64_tr_b16 v[224:225], v250 offset:15384
    ds_read_b64_tr_b16 v[226:227], v250 offset:16664
    ds_read_b64_tr_b16 v[228:229], v250 offset:15392
    buffer_load_dwordx4 v[120:123], v248, s[40:43], s52 offen offset:2048 sc1
    s_waitcnt lgkmcnt(11)
    v_mfma_f32_32x32x16_bf16 v[48:63], v[204:207], v[88:91], v[48:63]
    ds_read_b64_tr_b16 v[230:231], v250 offset:16672
    buffer_load_dwordx4 v[124:127], v248, s[40:43], s52 offen offset:3072 sc1
    s_waitcnt lgkmcnt(10)
    v_mfma_f32_32x32x16_bf16 v[64:79], v[208:211], v[88:91], v[64:79]
    buffer_load_dwordx4 v[128:131], v248, s[40:43], s53 offen offset:0 sc1
    s_waitcnt lgkmcnt(8)
    v_mfma_f32_32x32x16_bf16 v[0:15], v[212:215], v[92:95], v[0:15]
    ds_read_b64_tr_b16 v[192:193], v250 offset:20480
    ds_read_b64_tr_b16 v[194:195], v250 offset:21760
    ds_read_b64_tr_b16 v[196:197], v250 offset:20488
    buffer_load_dwordx4 v[132:135], v248, s[40:43], s53 offen offset:1024 sc1
    s_waitcnt lgkmcnt(9)
    v_mfma_f32_32x32x16_bf16 v[16:31], v[216:219], v[92:95], v[16:31]
    ds_read_b64_tr_b16 v[198:199], v250 offset:21768
    ds_read_b64_tr_b16 v[200:201], v250 offset:20496
    ds_read_b64_tr_b16 v[202:203], v250 offset:21776
    buffer_load_dwordx4 v[136:139], v248, s[40:43], s53 offen offset:2048 sc1
    s_waitcnt lgkmcnt(10)
    v_mfma_f32_32x32x16_bf16 v[32:47], v[220:223], v[92:95], v[32:47]
    ds_read_b64_tr_b16 v[204:205], v250 offset:20504
    ds_read_b64_tr_b16 v[206:207], v250 offset:21784
    ds_read_b64_tr_b16 v[208:209], v250 offset:20512
    buffer_load_dwordx4 v[140:143], v248, s[40:43], s53 offen offset:3072 sc1
    s_waitcnt lgkmcnt(11)
    v_mfma_f32_32x32x16_bf16 v[48:63], v[224:227], v[92:95], v[48:63]
    ds_read_b64_tr_b16 v[210:211], v250 offset:21792
    s_waitcnt lgkmcnt(10)
    v_mfma_f32_32x32x16_bf16 v[64:79], v[228:231], v[92:95], v[64:79]
    s_barrier
    s_waitcnt vmcnt(8)
    v_readlane_b32 s51, v145, 3
    s_nop 0
    s_cmp_lg_u32 s51, s100
    s_cbranch_scc1 L_rt_e3
L_ok_e3:
    s_waitcnt lgkmcnt(8)
    v_mfma_f32_32x32x16_bf16 v[0:15], v[192:195], v[96:99], v[0:15]
    ds_read_b64_tr_b16 v[212:213], v250 offset:25600
    ds_read_b64_tr_b16 v[214:215], v250 offset:26880
    ds_read_b64_tr_b16 v[216:217], v250 offset:25608
    s_add_u32 s51, s99, 3
    s_and_b32 s51, s51, 3
    s_sub_u32 s51, s51, s99
    s_lshl_b32 s51, s51, 16
    s_add_u32 s52, s51, s59
    s_add_u32 s53, s51, s60
    buffer_load_dwordx4 v[160:163], v248, s[40:43], s52 offen offset:0 sc1
    s_waitcnt lgkmcnt(9)
    v_mfma_f32_32x32x16_bf16 v[16:31], v[196:199], v[96:99], v[16:31]
    ds_read_b64_tr_b16 v[218:219], v250 offset:26888
    ds_read_b64_tr_b16 v[220:221], v250 offset:25616
    ds_read_b64_tr_b16 v[222:223], v250 offset:26896
    buffer_load_dwordx4 v[164:167], v248, s[40:43], s52 offen offset:1024 sc1
    s_waitcnt lgkmcnt(10)
    v_mfma_f32_32x32x16_bf16 v[32:47], v[200:203], v[96:99], v[32:47]
    ds_read_b64_tr_b16 v[224:225], v250 offset:25624
    ds_read_b64_tr_b16 v[226:227], v250 offset:26904
    ds_read_b64_tr_b16 v[228:229], v250 offset:25632
    buffer_load_dwordx4 v[168:171], v248, s[40:43], s52 offen offset:2048 sc1
    s_waitcnt lgkmcnt(11)
    v_mfma_f32_32x32x16_bf16 v[48:63], v[204:207], v[96:99], v[48:63]
    ds_read_b64_tr_b16 v[230:231], v250 offset:26912
    buffer_load_dwordx4 v[172:175], v248, s[40:43], s52 offen offset:3072 sc1
    s_waitcnt lgkmcnt(10)
    v_mfma_f32_32x32x16_bf16 v[64:79], v[208:211], v[96:99], v[64:79]
    buffer_load_dwordx4 v[176:179], v248, s[40:43], s53 offen offset:0 sc1
    s_waitcnt lgkmcnt(8)
    v_mfma_f32_32x32x16_bf16 v[0:15], v[212:215], v[100:103], v[0:15]
    ds_read_b64_tr_b16 v[192:193], v250 offset:30720
    ds_read_b64_tr_b16 v[194:195], v250 offset:32000
    ds_read_b64_tr_b16 v[196:197], v250 offset:30728
    buffer_load_dwordx4 v[180:183], v248, s[40:43], s53 offen offset:1024 sc1
    s_waitcnt lgkmcnt(9)
    v_mfma_f32_32x32x16_bf16 v[16:31], v[216:219], v[100:103], v[16:31]
    ds_read_b64_tr_b16 v[198:199], v250 offset:32008
    ds_read_b64_tr_b16 v[200:201], v250 offset:30736
    ds_read_b64_tr_b16 v[202:203], v250 offset:32016
    buffer_load_dwordx4 v[184:187], v248, s[40:43], s53 offen offset:2048 sc1
    s_waitcnt lgkmcnt(10)
    v_mfma_f32_32x32x16_bf16 v[32:47], v[220:223], v[100:103], v[32:47]
    ds_read_b64_tr_b16 v[204:205], v250 offset:30744
    ds_read_b64_tr_b16 v[206:207], v250 offset:32024
    ds_read_b64_tr_b16 v[208:209], v250 offset:30752
    buffer_load_dwordx4 v[188:191], v248, s[40:43], s53 offen offset:3072 sc1
    s_add_u32 m0, s66, 40960
    s_waitcnt lgkmcnt(11)
    v_mfma_f32_32x32x16_bf16 v[48:63], v[224:227], v[100:103], v[48:63]
    ds_read_b64_tr_b16 v[210:211], v250 offset:32032
    s_add_u32 s51, s99, 3
    s_and_b32 s51, s51, 3
    s_lshl_b32 s51, s51, 1
    s_xor_b32 s51, s51, s68
    s_mul_i32 s51, s51, 163840
    s_add_u32 s57, s51, s65
    buffer_load_dwordx4 v251, s[36:39], s57 offen lds
    s_add_u32 m0, s66, 41984
    s_waitcnt lgkmcnt(10)
    v_mfma_f32_32x32x16_bf16 v[64:79], v[228:231], v[100:103], v[64:79]
    buffer_load_dwordx4 v252, s[36:39], s57 offen lds
    s_add_u32 m0, s66, 43008
    s_nop 0
    buffer_load_dwordx4 v253, s[36:39], s57 offen lds
    s_add_u32 m0, s66, 44032
    s_nop 0
    buffer_load_dwordx4 v254, s[36:39], s57 offen lds
    s_add_u32 m0, s66, 45056
    s_nop 0
    buffer_load_dwordx4 v255, s[36:39], s57 offen lds
    s_barrier
    s_waitcnt lgkmcnt(8)
    v_mfma_f32_32x32x16_bf16 v[0:15], v[192:195], v[104:107], v[0:15]
    ds_read_b64_tr_b16 v[212:213], v250 offset:35840
    ds_read_b64_tr_b16 v[214:215], v250 offset:37120
    ds_read_b64_tr_b16 v[216:217], v250 offset:35848
    s_waitcnt lgkmcnt(9)
    v_mfma_f32_32x32x16_bf16 v[16:31], v[196:199], v[104:107], v[16:31]
    ds_read_b64_tr_b16 v[218:219], v250 offset:37128
    ds_read_b64_tr_b16 v[220:221], v250 offset:35856
    ds_read_b64_tr_b16 v[222:223], v250 offset:37136
    s_waitcnt lgkmcnt(10)
    v_mfma_f32_32x32x16_bf16 v[32:47], v[200:203], v[104:107], v[32:47]
    ds_read_b64_tr_b16 v[224:225], v250 offset:35864
    ds_read_b64_tr_b16 v[226:227], v250 offset:37144
    ds_read_b64_tr_b16 v[228:229], v250 offset:35872
    s_waitcnt lgkmcnt(11)
    v_mfma_f32_32x32x16_bf16 v[48:63], v[204:207], v[104:107], v[48:63]
    ds_read_b64_tr_b16 v[230:231], v250 offset:37152
    s_waitcnt lgkmcnt(10)
    v_mfma_f32_32x32x16_bf16 v[64:79], v[208:211], v[104:107], v[64:79]
    s_waitcnt lgkmcnt(8)
    v_mfma_f32_32x32x16_bf16 v[0:15], v[212:215], v[108:111], v[0:15]
    ds_read_b64_tr_b16 v[192:193], v249 offset:0
    ds_read_b64_tr_b16 v[194:195], v249 offset:1280
    ds_read_b64_tr_b16 v[196:197], v249 offset:8
    s_waitcnt lgkmcnt(9)
    v_mfma_f32_32x32x16_bf16 v[16:31], v[216:219], v[108:111], v[16:31]
    ds_read_b64_tr_b16 v[198:199], v249 offset:1288
    ds_read_b64_tr_b16 v[200:201], v249 offset:16
    ds_read_b64_tr_b16 v[202:203], v249 offset:1296
    s_waitcnt lgkmcnt(10)
    v_mfma_f32_32x32x16_bf16 v[32:47], v[220:223], v[108:111], v[32:47]
    ds_read_b64_tr_b16 v[204:205], v249 offset:24
    ds_read_b64_tr_b16 v[206:207], v249 offset:1304
    ds_read_b64_tr_b16 v[208:209], v249 offset:32
    s_waitcnt lgkmcnt(11)
    v_mfma_f32_32x32x16_bf16 v[48:63], v[224:227], v[108:111], v[48:63]
    ds_read_b64_tr_b16 v[210:211], v249 offset:1312
    s_waitcnt lgkmcnt(10)
    v_mfma_f32_32x32x16_bf16 v[64:79], v[228:231], v[108:111], v[64:79]
    s_waitcnt vmcnt(0)
    s_barrier
    s_add_u32 m0, s66, 61440
    s_waitcnt lgkmcnt(8)
    v_mfma_f32_32x32x16_bf16 v[0:15], v[192:195], v[112:115], v[0:15]
    ds_read_b64_tr_b16 v[212:213], v249 offset:5120
    ds_read_b64_tr_b16 v[214:215], v249 offset:6400
    ds_read_b64_tr_b16 v[216:217], v249 offset:5128
    buffer_load_dword v145, v233, s[40:43], s45 offen offset:512 sc1
    s_add_u32 s51, s99, 3
    s_and_b32 s51, s51, 3
    s_lshl_b32 s51, s51, 1
    s_xor_b32 s51, s51, s68
    s_mul_i32 s51, s51, 163840
    s_add_u32 s57, s51, s65
    s_add_u32 s58, s57, 81920
    buffer_load_dwordx4 v251, s[36:39], s58 offen lds
    s_waitcnt lgkmcnt(9)
    v_mfma_f32_32x32x16_bf16 v[16:31], v[196:199], v[112:115], v[16:31]
    ds_read_b64_tr_b16 v[218:219], v249 offset:6408
    ds_read_b64_tr_b16 v[220:221], v249 offset:5136
    ds_read_b64_tr_b16 v[222:223], v249 offset:6416
    s_add_u32 m0, s66, 62464
    s_waitcnt lgkmcnt(10)
    v_mfma_f32_32x32x16_bf16 v[32:47], v[200:203], v[112:115], v[32:47]
    ds_read_b64_tr_b16 v[224:225], v249 offset:5144
    ds_read_b64_tr_b16 v[226:227], v249 offset:6424
    ds_read_b64_tr_b16 v[228:229], v249 offset:5152
    buffer_load_dwordx4 v252, s[36:39], s58 offen lds
    s_waitcnt lgkmcnt(11)
    v_mfma_f32_32x32x16_bf16 v[48:63], v[204:207], v[112:115], v[48:63]
    ds_read_b64_tr_b16 v[230:231], v249 offset:6432
    s_add_u32 m0, s66, 63488
    s_waitcnt lgkmcnt(10)
    v_mfma_f32_32x32x16_bf16 v[64:79], v[208:211], v[112:115], v[64:79]
    buffer_load_dwordx4 v253, s[36:39], s58 offen lds
    s_waitcnt lgkmcnt(8)
    v_mfma_f32_32x32x16_bf16 v[0:15], v[212:215], v[116:119], v[0:15]
    ds_read_b64_tr_b16 v[192:193], v249 offset:10240
    ds_read_b64_tr_b16 v[194:195], v249 offset:11520
    ds_read_b64_tr_b16 v[196:197], v249 offset:10248
    s_add_u32 m0, s66, 64512
    s_waitcnt lgkmcnt(9)
    v_mfma_f32_32x32x16_bf16 v[16:31], v[216:219], v[116:119], v[16:31]
    ds_read_b64_tr_b16 v[198:199], v249 offset:11528
    ds_read_b64_tr_b16 v[200:201], v249 offset:10256
    ds_read_b64_tr_b16 v[202:203], v249 offset:11536
    buffer_load_dwordx4 v254, s[36:39], s58 offen lds
    s_waitcnt lgkmcnt(10)
    v_mfma_f32_32x32x16_bf16 v[32:47], v[220:223], v[116:119], v[32:47]
    ds_read_b64_tr_b16 v[204:205], v249 offset:10264
    ds_read_b64_tr_b16 v[206:207], v249 offset:11544
    ds_read_b64_tr_b16 v[208:209], v249 offset:10272
    s_add_u32 m0, s66, 65536
    s_waitcnt lgkmcnt(11)
    v_mfma_f32_32x32x16_bf16 v[48:63], v[224:227], v[116:119], v[48:63]
    ds_read_b64_tr_b16 v[210:211], v249 offset:11552
    buffer_load_dwordx4 v255, s[36:39], s58 offen lds
    s_waitcnt lgkmcnt(10)
    v_mfma_f32_32x32x16_bf16 v[64:79], v[228:231], v[116:119], v[64:79]
    s_waitcnt lgkmcnt(8)
    v_mfma_f32_32x32x16_bf16 v[0:15], v[192:195], v[120:123], v[0:15]
    ds_read_b64_tr_b16 v[212:213], v249 offset:15360
    ds_read_b64_tr_b16 v[214:215], v249 offset:16640
    ds_read_b64_tr_b16 v[216:217], v249 offset:15368
    s_waitcnt lgkmcnt(9)
    v_mfma_f32_32x32x16_bf16 v[16:31], v[196:199], v[120:123], v[16:31]
    ds_read_b64_tr_b16 v[218:219], v249 offset:16648
    ds_read_b64_tr_b16 v[220:221], v249 offset:15376
    ds_read_b64_tr_b16 v[222:223], v249 offset:16656
    s_waitcnt lgkmcnt(10)
    v_mfma_f32_32x32x16_bf16 v[32:47], v[200:203], v[120:123], v[32:47]
    ds_read_b64_tr_b16 v[224:225], v249 offset:15384
    ds_read_b64_tr_b16 v[226:227], v249 offset:16664
    ds_read_b64_tr_b16 v[228:229], v249 offset:15392
    s_waitcnt lgkmcnt(11)
    v_mfma_f32_32x32x16_bf16 v[48:63], v[204:207], v[120:123], v[48:63]
    ds_read_b64_tr_b16 v[230:231], v249 offset:16672
    s_waitcnt lgkmcnt(10)
    v_mfma_f32_32x32x16_bf16 v[64:79], v[208:211], v[120:123], v[64:79]
    s_waitcnt lgkmcnt(8)
    v_mfma_f32_32x32x16_bf16 v[0:15], v[212:215], v[124:127], v[0:15]
    ds_read_b64_tr_b16 v[192:193], v249 offset:20480
    ds_read_b64_tr_b16 v[194:195], v249 offset:21760
    ds_read_b64_tr_b16 v[196:197], v249 offset:20488
    s_waitcnt lgkmcnt(9)
    v_mfma_f32_32x32x16_bf16 v[16:31], v[216:219], v[124:127], v[16:31]
    ds_read_b64_tr_b16 v[198:199], v249 offset:21768
    ds_read_b64_tr_b16 v[200:201], v249 offset:20496
    ds_read_b64_tr_b16 v[202:203], v249 offset:21776
    s_waitcnt lgkmcnt(10)
    v_mfma_f32_32x32x16_bf16 v[32:47], v[220:223], v[124:127], v[32:47]
    ds_read_b64_tr_b16 v[204:205], v249 offset:20504
    ds_read_b64_tr_b16 v[206:207], v249 offset:21784
    ds_read_b64_tr_b16 v[208:209], v249 offset:20512
    s_waitcnt lgkmcnt(11)
    v_mfma_f32_32x32x16_bf16 v[48:63], v[224:227], v[124:127], v[48:63]
    ds_read_b64_tr_b16 v[210:211], v249 offset:21792
    s_waitcnt lgkmcnt(10)
    v_mfma_f32_32x32x16_bf16 v[64:79], v[228:231], v[124:127], v[64:79]
    s_waitcnt lgkmcnt(8)
    v_mfma_f32_32x32x16_bf16 v[0:15], v[192:195], v[128:131], v[0:15]
    ds_read_b64_tr_b16 v[212:213], v249 offset:25600
    ds_read_b64_tr_b16 v[214:215], v249 offset:26880
    ds_read_b64_tr_b16 v[216:217], v249 offset:25608
    s_waitcnt lgkmcnt(9)
    v_mfma_f32_32x32x16_bf16 v[16:31], v[196:199], v[128:131], v[16:31]
    ds_read_b64_tr_b16 v[218:219], v249 offset:26888
    ds_read_b64_tr_b16 v[220:221], v249 offset:25616
    ds_read_b64_tr_b16 v[222:223], v249 offset:26896
    s_waitcnt lgkmcnt(10)
    v_mfma_f32_32x32x16_bf16 v[32:47], v[200:203], v[128:131], v[32:47]
    ds_read_b64_tr_b16 v[224:225], v249 offset:25624
    ds_read_b64_tr_b16 v[226:227], v249 offset:26904
    ds_read_b64_tr_b16 v[228:229], v249 offset:25632
    s_waitcnt lgkmcnt(11)
    v_mfma_f32_32x32x16_bf16 v[48:63], v[204:207], v[128:131], v[48:63]
    ds_read_b64_tr_b16 v[230:231], v249 offset:26912
    s_waitcnt lgkmcnt(10)
    v_mfma_f32_32x32x16_bf16 v[64:79], v[208:211], v[128:131], v[64:79]
    s_waitcnt lgkmcnt(8)
    v_mfma_f32_32x32x16_bf16 v[0:15], v[212:215], v[132:135], v[0:15]
    ds_read_b64_tr_b16 v[192:193], v249 offset:30720
    ds_read_b64_tr_b16 v[194:195], v249 offset:32000
    ds_read_b64_tr_b16 v[196:197], v249 offset:30728
    s_waitcnt lgkmcnt(9)
    v_mfma_f32_32x32x16_bf16 v[16:31], v[216:219], v[132:135], v[16:31]
    ds_read_b64_tr_b16 v[198:199], v249 offset:32008
    ds_read_b64_tr_b16 v[200:201], v249 offset:30736
    ds_read_b64_tr_b16 v[202:203], v249 offset:32016
    s_waitcnt lgkmcnt(10)
    v_mfma_f32_32x32x16_bf16 v[32:47], v[220:223], v[132:135], v[32:47]
    ds_read_b64_tr_b16 v[204:205], v249 offset:30744
    ds_read_b64_tr_b16 v[206:207], v249 offset:32024
    ds_read_b64_tr_b16 v[208:209], v249 offset:30752
    s_waitcnt lgkmcnt(11)
    v_mfma_f32_32x32x16_bf16 v[48:63], v[224:227], v[132:135], v[48:63]
    ds_read_b64_tr_b16 v[210:211], v249 offset:32032
    s_waitcnt lgkmcnt(10)
    v_mfma_f32_32x32x16_bf16 v[64:79], v[228:231], v[132:135], v[64:79]
    s_waitcnt lgkmcnt(8)
    v_mfma_f32_32x32x16_bf16 v[0:15], v[192:195], v[136:139], v[0:15]
    ds_read_b64_tr_b16 v[212:213], v249 offset:35840
    ds_read_b64_tr_b16 v[214:215], v249 offset:37120
    ds_read_b64_tr_b16 v[216:217], v249 offset:35848
    s_waitcnt lgkmcnt(9)
    v_mfma_f32_32x32x16_bf16 v[16:31], v[196:199], v[136:139], v[16:31]
    ds_read_b64_tr_b16 v[218:219], v249 offset:37128
    ds_read_b64_tr_b16 v[220:221], v249 offset:35856
    ds_read_b64_tr_b16 v[222:223], v249 offset:37136
    s_waitcnt lgkmcnt(10)
    v_mfma_f32_32x32x16_bf16 v[32:47], v[200:203], v[136:139], v[32:47]
    ds_read_b64_tr_b16 v[224:225], v249 offset:35864
    ds_read_b64_tr_b16 v[226:227], v249 offset:37144
    ds_read_b64_tr_b16 v[228:229], v249 offset:35872
    s_waitcnt lgkmcnt(11)
    v_mfma_f32_32x32x16_bf16 v[48:63], v[204:207], v[136:139], v[48:63]
    ds_read_b64_tr_b16 v[230:231], v249 offset:37152
    s_waitcnt lgkmcnt(10)
    v_mfma_f32_32x32x16_bf16 v[64:79], v[208:211], v[136:139], v[64:79]
    s_waitcnt lgkmcnt(8)
    v_mfma_f32_32x32x16_bf16 v[0:15], v[212:215], v[140:143], v[0:15]
    ds_read_b64_tr_b16 v[192:193], v250 offset:0
    ds_read_b64_tr_b16 v[194:195], v250 offset:1280
    ds_read_b64_tr_b16 v[196:197], v250 offset:8
    s_waitcnt lgkmcnt(9)
    v_mfma_f32_32x32x16_bf16 v[16:31], v[216:219], v[140:143], v[16:31]
    ds_read_b64_tr_b16 v[198:199], v250 offset:1288
    ds_read_b64_tr_b16 v[200:201], v250 offset:16
    ds_read_b64_tr_b16 v[202:203], v250 offset:1296
    s_waitcnt lgkmcnt(10)
    v_mfma_f32_32x32x16_bf16 v[32:47], v[220:223], v[140:143], v[32:47]
    ds_read_b64_tr_b16 v[204:205], v250 offset:24
    ds_read_b64_tr_b16 v[206:207], v250 offset:1304
    ds_read_b64_tr_b16 v[208:209], v250 offset:32
    s_waitcnt lgkmcnt(11)
    v_mfma_f32_32x32x16_bf16 v[48:63], v[224:227], v[140:143], v[48:63]
    ds_read_b64_tr_b16 v[210:211], v250 offset:1312
    s_waitcnt lgkmcnt(10)
    v_mfma_f32_32x32x16_bf16 v[64:79], v[228:231], v[140:143], v[64:79]
    s_mov_b32 s4, 14
    s_mov_b32 s6, 0
    s_lshl_b32 s54, s49, 2
    s_add_u32 s54, s54, s99
    s_lshl_b32 s54, s54, 2
    s_add_u32 s54, s54, s96
    s_lshl_b32 s46, s54, 7
    s_add_u32 s46, s46, 42008576
    s_mul_i32 s54, s54, 36864
    s_add_u32 s54, s54, 16777216
    s_mul_i32 s51, s98, 9216
    s_add_u32 s56, s54, s51
    s_add_u32 s55, s56, 4096
    s_add_u32 s44, s56, 6144
    s_and_b32 s69, s100, 0x1fff
    s_or_b32 s69, s69, 0x4000
    s_lshl_b32 s69, s69, 16
    s_sub_u32 s51, s98, 3
    s_and_b32 s51, s51, 3
    s_mul_i32 s51, s51, 9216
    s_add_u32 s51, s51, 4096
    s_add_u32 s64, s51, s54
    s_sub_u32 s51, s98, 2
    s_and_b32 s51, s51, 3
    s_mul_i32 s51, s51, 9216
    s_add_u32 s51, s51, 2048
    s_add_u32 s47, s51, s54
    s_sub_u32 s51, s98, 1
    s_and_b32 s51, s51, 3
    s_mul_i32 s51, s51, 9216
    s_add_u32 s51, s51, 0
    s_add_u32 s54, s51, s54
    s_lshl_b32 s62, s98, 2
    s_add_u32 s62, s62, s46
    s_mov_b32 s20, s14
    s_mov_b32 s21, s15
    s_mov_b32 s22, 2621440
    s_mov_b32 s23, 0x20000
    v_and_b32 v245, 31, v243
    v_lshrrev_b32 v246, 5, v243
    v_lshl_add_u32 v245, v245, 1, v246
    v_lshlrev_b32 v245, 3, v245
    v_add_u32 v245, 3072, v245
    v_and_b32 v236, 31, v243
    v_mul_u32_u24 v236, 1280, v236
    v_lshrrev_b32 v246, 5, v243
    v_mul_u32_u24 v246, 40, v246
    v_add_u32 v236, v236, v246
    s_lshl_b32 s63, s49, 2
    s_add_u32 s63, s63, s96
    s_mul_i32 s63, s63, 40960
    s_mul_i32 s51, s99, 320
    s_add_u32 s63, s63, s51
    s_mul_i32 s51, s98, 80
    s_add_u32 s63, s63, s51
    s_waitcnt vmcnt(5)
    v_cmp_eq_u32 vcc, s100, v145
    s_nop 0
    s_mov_b32 s5, vcc_lo
    s_barrier
    s_waitcnt lgkmcnt(8)
    v_mfma_f32_32x32x16_bf16 v[0:15], v[192:195], v[160:163], v[0:15]
    ds_read_b64_tr_b16 v[212:213], v250 offset:5120
    ds_read_b64_tr_b16 v[214:215], v250 offset:6400
    ds_read_b64_tr_b16 v[216:217], v250 offset:5128
    ds_read_b128 v[80:83], v244 offset:0
    ds_read_b128 v[84:87], v244 offset:1024
    s_waitcnt lgkmcnt(11)
    v_mfma_f32_32x32x16_bf16 v[16:31], v[196:199], v[160:163], v[16:31]
    ds_read_b64_tr_b16 v[218:219], v250 offset:6408
    ds_read_b64_tr_b16 v[220:221], v250 offset:5136
    ds_read_b64_tr_b16 v[222:223], v250 offset:6416
    ds_read_b128 v[88:91], v244 offset:2048
    ds_read_b128 v[92:95], v244 offset:3072
    s_waitcnt lgkmcnt(14)
    v_mfma_f32_32x32x16_bf16 v[32:47], v[200:203], v[160:163], v[32:47]
    ds_read_b64_tr_b16 v[224:225], v250 offset:5144
    ds_read_b64_tr_b16 v[226:227], v250 offset:6424
    ds_read_b64_tr_b16 v[228:229], v250 offset:5152
    ds_read_b128 v[96:99], v244 offset:4096
    ds_read_b128 v[100:103], v244 offset:5120
    s_waitcnt lgkmcnt(15)
    v_mfma_f32_32x32x16_bf16 v[48:63], v[204:207], v[160:163], v[48:63]
    ds_read_b64_tr_b16 v[230:231], v250 offset:6432
    ds_read_b128 v[104:107], v244 offset:6144
    ds_read_b128 v[108:111], v244 offset:7168
    v_mfma_f32_32x32x16_bf16 v[64:79], v[208:211], v[160:163], v[64:79]
    s_waitcnt lgkmcnt(15)
    v_mfma_f32_32x32x16_bf16 v[0:15], v[212:215], v[164:167], v[0:15]
    ds_read_b64_tr_b16 v[192:193], v250 offset:10240
    ds_read_b64_tr_b16 v[194:195], v250 offset:11520
    ds_read_b64_tr_b16 v[196:197], v250 offset:10248
    s_waitcnt lgkmcnt(15)
    v_mfma_f32_32x32x16_bf16 v[16:31], v[216:219], v[164:167], v[16:31]
    ds_read_b64_tr_b16 v[198:199], v250 offset:11528
    ds_read_b64_tr_b16 v[200:201], v250 offset:10256
    ds_read_b64_tr_b16 v[202:203], v250 offset:11536
    s_waitcnt vmcnt(0)
    s_waitcnt lgkmcnt(6)
    s_barrier
    s_cmp_eq_u32 s6, 0
    s_cselect_b32 s51, 2, 0
    s_and_b32 s51, s51, s4
    s_and_b32 s51, s51, s5
    s_cbranch_scc0 L_t1
    s_ff1_i32_b32 s7, s51
    s_bitset0_b32 s4, s7
    s_mov_b32 s6, 1
    s_add_u32 s51, s99, s7
    s_and_b32 s51, s51, 3
    s_sub_u32 s51, s51, s99
    s_lshl_b32 s51, s51, 16
    s_add_u32 s51, s51, 32768
    s_add_u32 s52, s51, s59
    s_add_u32 s53, s51, s60
    buffer_load_dwordx4 v[112:115], v248, s[40:43], s52 offen offset:0 sc1
    buffer_load_dwordx4 v[116:119], v248, s[40:43], s52 offen offset:1024 sc1
    buffer_load_dwordx4 v[120:123], v248, s[40:43], s52 offen offset:2048 sc1
    buffer_load_dwordx4 v[124:127], v248, s[40:43], s52 offen offset:3072 sc1
    buffer_load_dwordx4 v[128:131], v248, s[40:43], s53 offen offset:0 sc1
    buffer_load_dwordx4 v[132:135], v248, s[40:43], s53 offen offset:1024 sc1
    buffer_load_dwordx4 v[136:139], v248, s[40:43], s53 offen offset:2048 sc1
    buffer_load_dwordx4 v[140:143], v248, s[40:43], s53 offen offset:3072 sc1
L_t1:
    v_mfma_f32_32x32x16_bf16 v[32:47], v[220:223], v[164:167], v[32:47]
    ds_read_b64_tr_b16 v[204:205], v250 offset:10264
    ds_read_b64_tr_b16 v[206:207], v250 offset:11544
    ds_read_b64_tr_b16 v[208:209], v250 offset:10272
    v_mfma_f32_32x32x16_bf16 v[48:63], v[224:227], v[164:167], v[48:63]
    ds_read_b64_tr_b16 v[210:211], v250 offset:11552
    v_mfma_f32_32x32x16_bf16 v[64:79], v[228:231], v[164:167], v[64:79]
    s_waitcnt lgkmcnt(8)
    v_mfma_f32_32x32x16_bf16 v[0:15], v[192:195], v[168:171], v[0:15]
    ds_read_b64_tr_b16 v[212:213], v250 offset:15360
    ds_read_b64_tr_b16 v[214:215], v250 offset:16640
    ds_read_b64_tr_b16 v[216:217], v250 offset:15368
    buffer_load_dword v145, v233, s[40:43], s45 offen offset:512 sc1
    s_waitcnt lgkmcnt(9)
    v_mfma_f32_32x32x16_bf16 v[16:31], v[196:199], v[168:171], v[16:31]
    ds_read_b64_tr_b16 v[218:219], v250 offset:16648
    ds_read_b64_tr_b16 v[220:221], v250 offset:15376
    ds_read_b64_tr_b16 v[222:223], v250 offset:16656
    s_waitcnt lgkmcnt(10)
    v_mfma_f32_32x32x16_bf16 v[32:47], v[200:203], v[168:171], v[32:47]
    ds_read_b64_tr_b16 v[224:225], v250 offset:15384
    ds_read_b64_tr_b16 v[226:227], v250 offset:16664
    ds_read_b64_tr_b16 v[228:229], v250 offset:15392
    s_waitcnt lgkmcnt(11)
    v_mfma_f32_32x32x16_bf16 v[48:63], v[204:207], v[168:171], v[48:63]
    ds_read_b64_tr_b16 v[230:231], v250 offset:16672
    s_waitcnt lgkmcnt(10)
    v_mfma_f32_32x32x16_bf16 v[64:79], v[208:211], v[168:171], v[64:79]
    s_waitcnt lgkmcnt(8)
    v_mfma_f32_32x32x16_bf16 v[0:15], v[212:215], v[172:175], v[0:15]
    ds_read_b64_tr_b16 v[192:193], v250 offset:20480
    ds_read_b64_tr_b16 v[194:195], v250 offset:21760
    ds_read_b64_tr_b16 v[196:197], v250 offset:20488
    s_waitcnt lgkmcnt(9)
    v_mfma_f32_32x32x16_bf16 v[16:31], v[216:219], v[172:175], v[16:31]
    ds_read_b64_tr_b16 v[198:199], v250 offset:21768
    ds_read_b64_tr_b16 v[200:201], v250 offset:20496
    ds_read_b64_tr_b16 v[202:203], v250 offset:21776
    s_waitcnt lgkmcnt(10)
    v_mfma_f32_32x32x16_bf16 v[32:47], v[220:223], v[172:175], v[32:47]
    ds_read_b64_tr_b16 v[204:205], v250 offset:20504
    ds_read_b64_tr_b16 v[206:207], v250 offset:21784
    ds_read_b64_tr_b16 v[208:209], v250 offset:20512
    s_waitcnt lgkmcnt(11)
    v_mfma_f32_32x32x16_bf16 v[48:63], v[224:227], v[172:175], v[48:63]
    ds_read_b64_tr_b16 v[210:211], v250 offset:21792
    s_waitcnt lgkmcnt(10)
    v_mfma_f32_32x32x16_bf16 v[64:79], v[228:231], v[172:175], v[64:79]
    s_waitcnt lgkmcnt(8)
    v_mfma_f32_32x32x16_bf16 v[0:15], v[192:195], v[176:179], v[0:15]
    ds_read_b64_tr_b16 v[212:213], v250 offset:25600
    ds_read_b64_tr_b16 v[214:215], v250 offset:26880
    ds_read_b64_tr_b16 v[216:217], v250 offset:25608
    s_waitcnt lgkmcnt(9)
    v_mfma_f32_32x32x16_bf16 v[16:31], v[196:199], v[176:179], v[16:31]
    ds_read_b64_tr_b16 v[218:219], v250 offset:26888
    ds_read_b64_tr_b16 v[220:221], v250 offset:25616
    ds_read_b64_tr_b16 v[222:223], v250 offset:26896
    s_waitcnt lgkmcnt(10)
    v_mfma_f32_32x32x16_bf16 v[32:47], v[200:203], v[176:179], v[32:47]
    ds_read_b64_tr_b16 v[224:225], v250 offset:25624
    ds_read_b64_tr_b16 v[226:227], v250 offset:26904
    ds_read_b64_tr_b16 v[228:229], v250 offset:25632
    s_waitcnt lgkmcnt(11)
    v_mfma_f32_32x32x16_bf16 v[48:63], v[204:207], v[176:179], v[48:63]
    ds_read_b64_tr_b16 v[230:231], v250 offset:26912
    s_waitcnt lgkmcnt(10)
    v_mfma_f32_32x32x16_bf16 v[64:79], v[208:211], v[176:179], v[64:79]
    s_waitcnt lgkmcnt(8)
    v_mfma_f32_32x32x16_bf16 v[0:15], v[212:215], v[180:183], v[0:15]
    ds_read_b64_tr_b16 v[192:193], v250 offset:30720
    ds_read_b64_tr_b16 v[194:195], v250 offset:32000
    ds_read_b64_tr_b16 v[196:197], v250 offset:30728
    s_waitcnt lgkmcnt(9)
    v_mfma_f32_32x32x16_bf16 v[16:31], v[216:219], v[180:183], v[16:31]
    ds_read_b64_tr_b16 v[198:199], v250 offset:32008
    ds_read_b64_tr_b16 v[200:201], v250 offset:30736
    ds_read_b64_tr_b16 v[202:203], v250 offset:32016
    s_waitcnt lgkmcnt(10)
    v_mfma_f32_32x32x16_bf16 v[32:47], v[220:223], v[180:183], v[32:47]
    ds_read_b64_tr_b16 v[204:205], v250 offset:30744
    ds_read_b64_tr_b16 v[206:207], v250 offset:32024
    ds_read_b64_tr_b16 v[208:209], v250 offset:30752
    s_waitcnt lgkmcnt(11)
    v_mfma_f32_32x32x16_bf16 v[48:63], v[224:227], v[180:183], v[48:63]
    ds_read_b64_tr_b16 v[210:211], v250 offset:32032
    s_waitcnt lgkmcnt(10)
    v_mfma_f32_32x32x16_bf16 v[64:79], v[228:231], v[180:183], v[64:79]
    s_waitcnt lgkmcnt(8)
    v_mfma_f32_32x32x16_bf16 v[0:15], v[192:195], v[184:187], v[0:15]
    ds_read_b64_tr_b16 v[212:213], v250 offset:35840
    ds_read_b64_tr_b16 v[214:215], v250 offset:37120
    ds_read_b64_tr_b16 v[216:217], v250 offset:35848
    s_waitcnt lgkmcnt(9)
    v_mfma_f32_32x32x16_bf16 v[16:31], v[196:199], v[184:187], v[16:31]
    ds_read_b64_tr_b16 v[218:219], v250 offset:37128
    ds_read_b64_tr_b16 v[220:221], v250 offset:35856
    ds_read_b64_tr_b16 v[222:223], v250 offset:37136
    s_waitcnt lgkmcnt(10)
    v_mfma_f32_32x32x16_bf16 v[32:47], v[200:203], v[184:187], v[32:47]
    ds_read_b64_tr_b16 v[224:225], v250 offset:35864
    ds_read_b64_tr_b16 v[226:227], v250 offset:37144
    ds_read_b64_tr_b16 v[228:229], v250 offset:35872
    s_waitcnt lgkmcnt(11)
    v_mfma_f32_32x32x16_bf16 v[48:63], v[204:207], v[184:187], v[48:63]
    ds_read_b64_tr_b16 v[230:231], v250 offset:37152
    s_waitcnt lgkmcnt(10)
    v_mfma_f32_32x32x16_bf16 v[64:79], v[208:211], v[184:187], v[64:79]
    s_waitcnt lgkmcnt(8)
    v_mfma_f32_32x32x16_bf16 v[0:15], v[212:215], v[188:191], v[0:15]
    ds_read_b64_tr_b16 v[192:193], v234 offset:0
    ds_read_b64_tr_b16 v[194:195], v234 offset:1280
    ds_read_b64_tr_b16 v[196:197], v234 offset:8
    s_waitcnt lgkmcnt(9)
    v_mfma_f32_32x32x16_bf16 v[16:31], v[216:219], v[188:191], v[16:31]
    ds_read_b64_tr_b16 v[198:199], v234 offset:1288
    ds_read_b64_tr_b16 v[200:201], v234 offset:16
    ds_read_b64_tr_b16 v[202:203], v234 offset:1296
    s_waitcnt lgkmcnt(10)
    v_mfma_f32_32x32x16_bf16 v[32:47], v[220:223], v[188:191], v[32:47]
    ds_read_b64_tr_b16 v[204:205], v234 offset:24
    ds_read_b64_tr_b16 v[206:207], v234 offset:1304
    ds_read_b64_tr_b16 v[208:209], v234 offset:32
    s_waitcnt lgkmcnt(11)
    v_mfma_f32_32x32x16_bf16 v[48:63], v[224:227], v[188:191], v[48:63]
    ds_read_b64_tr_b16 v[210:211], v234 offset:1312
    s_waitcnt lgkmcnt(10)
    v_mfma_f32_32x32x16_bf16 v[64:79], v[228:231], v[188:191], v[64:79]
    s_waitcnt lgkmcnt(8)
    v_mfma_f32_32x32x16_bf16 v[0:15], v[192:195], v[80:83], v[0:15]
    ds_read_b64_tr_b16 v[212:213], v234 offset:5120
    ds_read_b64_tr_b16 v[214:215], v234 offset:6400
    ds_read_b64_tr_b16 v[216:217], v234 offset:5128
    s_waitcnt lgkmcnt(9)
    v_mfma_f32_32x32x16_bf16 v[16:31], v[196:199], v[80:83], v[16:31]
    ds_read_b64_tr_b16 v[218:219], v234 offset:6408
    ds_read_b64_tr_b16 v[220:221], v234 offset:5136
    ds_read_b64_tr_b16 v[222:223], v234 offset:6416
    s_waitcnt vmcnt(0)
    v_cmp_eq_u32 vcc, s100, v145
    s_nop 0
    s_mov_b32 s5, vcc_lo
    s_cmp_eq_u32 s6, 0
    s_cselect_b32 s51, 2, 0
    s_and_b32 s51, s51, s4
    s_and_b32 s51, s51, s5
    s_cbranch_scc0 L_t2
    s_ff1_i32_b32 s7, s51
    s_bitset0_b32 s4, s7
    s_mov_b32 s6, 1
    s_add_u32 s51, s99, s7
    s_and_b32 s51, s51, 3
    s_sub_u32 s51, s51, s99
    s_lshl_b32 s51, s51, 16
    s_add_u32 s51, s51, 32768
    s_add_u32 s52, s51, s59
    s_add_u32 s53, s51, s60
    buffer_load_dwordx4 v[112:115], v248, s[40:43], s52 offen offset:0 sc1
    buffer_load_dwordx4 v[116:119], v248, s[40:43], s52 offen offset:1024 sc1
    buffer_load_dwordx4 v[120:123], v248, s[40:43], s52 offen offset:2048 sc1
    buffer_load_dwordx4 v[124:127], v248, s[40:43], s52 offen offset:3072 sc1
    buffer_load_dwordx4 v[128:131], v248, s[40:43], s53 offen offset:0 sc1
    buffer_load_dwordx4 v[132:135], v248, s[40:43], s53 offen offset:1024 sc1
    buffer_load_dwordx4 v[136:139], v248, s[40:43], s53 offen offset:2048 sc1
    buffer_load_dwordx4 v[140:143], v248, s[40:43], s53 offen offset:3072 sc1
L_t2:
    s_cmp_eq_u32 s6, 1
    s_cselect_b32 s51, 4, 0
    s_and_b32 s51, s51, s4
    s_and_b32 s51, s51, s5
    s_cbranch_scc0 L_t3
    s_ff1_i32_b32 s7, s51
    s_bitset0_b32 s4, s7
    s_mov_b32 s6, 2
    s_add_u32 s51, s99, s7
    s_and_b32 s51, s51, 3
    s_sub_u32 s51, s51, s99
    s_lshl_b32 s51, s51, 16
    s_add_u32 s51, s51, 32768
    s_add_u32 s52, s51, s59
    s_add_u32 s53, s51, s60
    buffer_load_dwordx4 v[160:163], v248, s[40:43], s52 offen offset:0 sc1
    buffer_load_dwordx4 v[164:167], v248, s[40:43], s52 offen offset:1024 sc1
    buffer_load_dwordx4 v[168:171], v248, s[40:43], s52 offen offset:2048 sc1
    buffer_load_dwordx4 v[172:175], v248, s[40:43], s52 offen offset:3072 sc1
    buffer_load_dwordx4 v[176:179], v248, s[40:43], s53 offen offset:0 sc1
    buffer_load_dwordx4 v[180:183], v248, s[40:43], s53 offen offset:1024 sc1
    buffer_load_dwordx4 v[184:187], v248, s[40:43], s53 offen offset:2048 sc1
    buffer_load_dwordx4 v[188:191], v248, s[40:43], s53 offen offset:3072 sc1
L_t3:
    s_waitcnt lgkmcnt(10)
    v_mfma_f32_32x32x16_bf16 v[32:47], v[200:203], v[80:83], v[32:47]
    ds_read_b64_tr_b16 v[224:225], v234 offset:5144
    ds_read_b64_tr_b16 v[226:227], v234 offset:6424
    ds_read_b64_tr_b16 v[228:229], v234 offset:5152
    s_waitcnt lgkmcnt(11)
    v_mfma_f32_32x32x16_bf16 v[48:63], v[204:207], v[80:83], v[48:63]
    ds_read_b64_tr_b16 v[230:231], v234 offset:6432
    s_waitcnt lgkmcnt(10)
    v_mfma_f32_32x32x16_bf16 v[64:79], v[208:211], v[80:83], v[64:79]
    s_waitcnt lgkmcnt(8)
    v_mfma_f32_32x32x16_bf16 v[0:15], v[212:215], v[84:87], v[0:15]
    ds_read_b64_tr_b16 v[192:193], v234 offset:10240
    ds_read_b64_tr_b16 v[194:195], v234 offset:11520
    ds_read_b64_tr_b16 v[196:197], v234 offset:10248
    s_waitcnt lgkmcnt(9)
    v_mfma_f32_32x32x16_bf16 v[16:31], v[216:219], v[84:87], v[16:31]
    ds_read_b64_tr_b16 v[198:199], v234 offset:11528
    ds_read_b64_tr_b16 v[200:201], v234 offset:10256
    ds_read_b64_tr_b16 v[202:203], v234 offset:11536
    s_waitcnt lgkmcnt(10)
    v_mfma_f32_32x32x16_bf16 v[32:47], v[220:223], v[84:87], v[32:47]
    ds_read_b64_tr_b16 v[204:205], v234 offset:10264
    ds_read_b64_tr_b16 v[206:207], v234 offset:11544
    ds_read_b64_tr_b16 v[208:209], v234 offset:10272
    s_waitcnt lgkmcnt(11)
    v_mfma_f32_32x32x16_bf16 v[48:63], v[224:227], v[84:87], v[48:63]
    ds_read_b64_tr_b16 v[210:211], v234 offset:11552
    s_waitcnt lgkmcnt(10)
    v_mfma_f32_32x32x16_bf16 v[64:79], v[228:231], v[84:87], v[64:79]
    s_waitcnt lgkmcnt(8)
    v_mfma_f32_32x32x16_bf16 v[0:15], v[192:195], v[88:91], v[0:15]
    ds_read_b64_tr_b16 v[212:213], v234 offset:15360
    ds_read_b64_tr_b16 v[214:215], v234 offset:16640
    ds_read_b64_tr_b16 v[216:217], v234 offset:15368
    buffer_load_dword v145, v233, s[40:43], s45 offen offset:512 sc1
    s_waitcnt lgkmcnt(9)
    v_mfma_f32_32x32x16_bf16 v[16:31], v[196:199], v[88:91], v[16:31]
    ds_read_b64_tr_b16 v[218:219], v234 offset:16648
    ds_read_b64_tr_b16 v[220:221], v234 offset:15376
    ds_read_b64_tr_b16 v[222:223], v234 offset:16656
    s_waitcnt lgkmcnt(10)
    v_mfma_f32_32x32x16_bf16 v[32:47], v[200:203], v[88:91], v[32:47]
    ds_read_b64_tr_b16 v[224:225], v234 offset:15384
    ds_read_b64_tr_b16 v[226:227], v234 offset:16664
    ds_read_b64_tr_b16 v[228:229], v234 offset:15392
    s_waitcnt lgkmcnt(11)
    v_mfma_f32_32x32x16_bf16 v[48:63], v[204:207], v[88:91], v[48:63]
    ds_read_b64_tr_b16 v[230:231], v234 offset:16672
    s_waitcnt lgkmcnt(10)
    v_mfma_f32_32x32x16_bf16 v[64:79], v[208:211], v[88:91], v[64:79]
    s_waitcnt lgkmcnt(8)
    v_mfma_f32_32x32x16_bf16 v[0:15], v[212:215], v[92:95], v[0:15]
    ds_read_b64_tr_b16 v[192:193], v234 offset:20480
    ds_read_b64_tr_b16 v[194:195], v234 offset:21760
    ds_read_b64_tr_b16 v[196:197], v234 offset:20488
    s_waitcnt lgkmcnt(9)
    v_mfma_f32_32x32x16_bf16 v[16:31], v[216:219], v[92:95], v[16:31]
    ds_read_b64_tr_b16 v[198:199], v234 offset:21768
    ds_read_b64_tr_b16 v[200:201], v234 offset:20496
    ds_read_b64_tr_b16 v[202:203], v234 offset:21776
    s_waitcnt lgkmcnt(10)
    v_mfma_f32_32x32x16_bf16 v[32:47], v[220:223], v[92:95], v[32:47]
    ds_read_b64_tr_b16 v[204:205], v234 offset:20504
    ds_read_b64_tr_b16 v[206:207], v234 offset:21784
    ds_read_b64_tr_b16 v[208:209], v234 offset:20512
    s_waitcnt lgkmcnt(11)
    v_mfma_f32_32x32x16_bf16 v[48:63], v[224:227], v[92:95], v[48:63]
    ds_read_b64_tr_b16 v[210:211], v234 offset:21792
    s_waitcnt lgkmcnt(10)
    v_mfma_f32_32x32x16_bf16 v[64:79], v[228:231], v[92:95], v[64:79]
    s_waitcnt lgkmcnt(8)
    v_mfma_f32_32x32x16_bf16 v[0:15], v[192:195], v[96:99], v[0:15]
    ds_read_b64_tr_b16 v[212:213], v234 offset:25600
    ds_read_b64_tr_b16 v[214:215], v234 offset:26880
    ds_read_b64_tr_b16 v[216:217], v234 offset:25608
    s_waitcnt lgkmcnt(9)
    v_mfma_f32_32x32x16_bf16 v[16:31], v[196:199], v[96:99], v[16:31]
    ds_read_b64_tr_b16 v[218:219], v234 offset:26888
    ds_read_b64_tr_b16 v[220:221], v234 offset:25616
    ds_read_b64_tr_b16 v[222:223], v234 offset:26896
    s_waitcnt lgkmcnt(10)
    v_mfma_f32_32x32x16_bf16 v[32:47], v[200:203], v[96:99], v[32:47]
    ds_read_b64_tr_b16 v[224:225], v234 offset:25624
    ds_read_b64_tr_b16 v[226:227], v234 offset:26904
    ds_read_b64_tr_b16 v[228:229], v234 offset:25632
    s_waitcnt lgkmcnt(11)
    v_mfma_f32_32x32x16_bf16 v[48:63], v[204:207], v[96:99], v[48:63]
    ds_read_b64_tr_b16 v[230:231], v234 offset:26912
    s_waitcnt lgkmcnt(10)
    v_mfma_f32_32x32x16_bf16 v[64:79], v[208:211], v[96:99], v[64:79]
    s_waitcnt lgkmcnt(8)
    v_mfma_f32_32x32x16_bf16 v[0:15], v[212:215], v[100:103], v[0:15]
    ds_read_b64_tr_b16 v[192:193], v234 offset:30720
    ds_read_b64_tr_b16 v[194:195], v234 offset:32000
    ds_read_b64_tr_b16 v[196:197], v234 offset:30728
    s_waitcnt lgkmcnt(9)
    v_mfma_f32_32x32x16_bf16 v[16:31], v[216:219], v[100:103], v[16:31]
    ds_read_b64_tr_b16 v[198:199], v234 offset:32008
    ds_read_b64_tr_b16 v[200:201], v234 offset:30736
    ds_read_b64_tr_b16 v[202:203], v234 offset:32016
    s_waitcnt lgkmcnt(10)
    v_mfma_f32_32x32x16_bf16 v[32:47], v[220:223], v[100:103], v[32:47]
    ds_read_b64_tr_b16 v[204:205], v234 offset:30744
    ds_read_b64_tr_b16 v[206:207], v234 offset:32024
    ds_read_b64_tr_b16 v[208:209], v234 offset:30752
    s_waitcnt lgkmcnt(11)
    v_mfma_f32_32x32x16_bf16 v[48:63], v[224:227], v[100:103], v[48:63]
    ds_read_b64_tr_b16 v[210:211], v234 offset:32032
    s_waitcnt lgkmcnt(10)
    v_mfma_f32_32x32x16_bf16 v[64:79], v[228:231], v[100:103], v[64:79]
    s_waitcnt lgkmcnt(8)
    v_mfma_f32_32x32x16_bf16 v[0:15], v[192:195], v[104:107], v[0:15]
    ds_read_b64_tr_b16 v[212:213], v234 offset:35840
    ds_read_b64_tr_b16 v[214:215], v234 offset:37120
    ds_read_b64_tr_b16 v[216:217], v234 offset:35848
    s_waitcnt lgkmcnt(9)
    v_mfma_f32_32x32x16_bf16 v[16:31], v[196:199], v[104:107], v[16:31]
    ds_read_b64_tr_b16 v[218:219], v234 offset:37128
    ds_read_b64_tr_b16 v[220:221], v234 offset:35856
    ds_read_b64_tr_b16 v[222:223], v234 offset:37136
    s_waitcnt lgkmcnt(10)
    v_mfma_f32_32x32x16_bf16 v[32:47], v[200:203], v[104:107], v[32:47]
    ds_read_b64_tr_b16 v[224:225], v234 offset:35864
    ds_read_b64_tr_b16 v[226:227], v234 offset:37144
    ds_read_b64_tr_b16 v[228:229], v234 offset:35872
    s_waitcnt lgkmcnt(11)
    v_mfma_f32_32x32x16_bf16 v[48:63], v[204:207], v[104:107], v[48:63]
    ds_read_b64_tr_b16 v[230:231], v234 offset:37152
    s_waitcnt lgkmcnt(10)
    v_mfma_f32_32x32x16_bf16 v[64:79], v[208:211], v[104:107], v[64:79]
    s_cmp_eq_u32 s4, 0
    s_cbranch_scc1 L_nd1
    s_mov_b32 s61, 0x40000
L_nl1:
    s_waitcnt vmcnt(0)
    v_cmp_eq_u32 vcc, s100, v145
    s_nop 0
    s_mov_b32 s5, vcc_lo
    s_cmp_eq_u32 s6, 0
    s_cselect_b32 s51, 2, 0
    s_and_b32 s51, s51, s4
    s_and_b32 s51, s51, s5
    s_cbranch_scc0 L_t4
    s_ff1_i32_b32 s7, s51
    s_bitset0_b32 s4, s7
    s_mov_b32 s6, 1
    s_add_u32 s51, s99, s7
    s_and_b32 s51, s51, 3
    s_sub_u32 s51, s51, s99
    s_lshl_b32 s51, s51, 16
    s_add_u32 s51, s51, 32768
    s_add_u32 s52, s51, s59
    s_add_u32 s53, s51, s60
    buffer_load_dwordx4 v[112:115], v248, s[40:43], s52 offen offset:0 sc1
    buffer_load_dwordx4 v[116:119], v248, s[40:43], s52 offen offset:1024 sc1
    buffer_load_dwordx4 v[120:123], v248, s[40:43], s52 offen offset:2048 sc1
    buffer_load_dwordx4 v[124:127], v248, s[40:43], s52 offen offset:3072 sc1
    buffer_load_dwordx4 v[128:131], v248, s[40:43], s53 offen offset:0 sc1
    buffer_load_dwordx4 v[132:135], v248, s[40:43], s53 offen offset:1024 sc1
    buffer_load_dwordx4 v[136:139], v248, s[40:43], s53 offen offset:2048 sc1
    buffer_load_dwordx4 v[140:143], v248, s[40:43], s53 offen offset:3072 sc1
L_t4:
    s_cmp_eq_u32 s6, 1
    s_cselect_b32 s51, 4, 0
    s_and_b32 s51, s51, s4
    s_and_b32 s51, s51, s5
    s_cbranch_scc0 L_t5
    s_ff1_i32_b32 s7, s51
    s_bitset0_b32 s4, s7
    s_mov_b32 s6, 2
    s_add_u32 s51, s99, s7
    s_and_b32 s51, s51, 3
    s_sub_u32 s51, s51, s99
    s_lshl_b32 s51, s51, 16
    s_add_u32 s51, s51, 32768
    s_add_u32 s52, s51, s59
    s_add_u32 s53, s51, s60
    buffer_load_dwordx4 v[160:163], v248, s[40:43], s52 offen offset:0 sc1
    buffer_load_dwordx4 v[164:167], v248, s[40:43], s52 offen offset:1024 sc1
    buffer_load_dwordx4 v[168:171], v248, s[40:43], s52 offen offset:2048 sc1
    buffer_load_dwordx4 v[172:175], v248, s[40:43], s52 offen offset:3072 sc1
    buffer_load_dwordx4 v[176:179], v248, s[40:43], s53 offen offset:0 sc1
    buffer_load_dwordx4 v[180:183], v248, s[40:43], s53 offen offset:1024 sc1
    buffer_load_dwordx4 v[184:187], v248, s[40:43], s53 offen offset:2048 sc1
    buffer_load_dwordx4 v[188:191], v248, s[40:43], s53 offen offset:3072 sc1
L_t5:
    s_cmp_ge_u32 s6, 1
    s_cbranch_scc1 L_nd1
    buffer_load_dword v145, v233, s[40:43], s45 offen offset:512 sc1
    s_sub_u32 s61, s61, 1
    s_cmp_lg_u32 s61, 0
    s_cbranch_scc1 L_nl1
L_nd1:
    s_barrier
    s_waitcnt lgkmcnt(8)
    v_mfma_f32_32x32x16_bf16 v[0:15], v[212:215], v[108:111], v[0:15]
    ds_read_b64_tr_b16 v[192:193], v249 offset:0
    ds_read_b64_tr_b16 v[194:195], v249 offset:1280
    ds_read_b64_tr_b16 v[196:197], v249 offset:8
    s_waitcnt lgkmcnt(9)
    v_mfma_f32_32x32x16_bf16 v[16:31], v[216:219], v[108:111], v[16:31]
    ds_read_b64_tr_b16 v[198:199], v249 offset:1288
    ds_read_b64_tr_b16 v[200:201], v249 offset:16
    ds_read_b64_tr_b16 v[202:203], v249 offset:1296
    s_waitcnt lgkmcnt(10)
    v_mfma_f32_32x32x16_bf16 v[32:47], v[220:223], v[108:111], v[32:47]
    ds_read_b64_tr_b16 v[204:205], v249 offset:24
    ds_read_b64_tr_b16 v[206:207], v249 offset:1304
    ds_read_b64_tr_b16 v[208:209], v249 offset:32
    s_waitcnt lgkmcnt(11)
    v_mfma_f32_32x32x16_bf16 v[48:63], v[224:227], v[108:111], v[48:63]
    ds_read_b64_tr_b16 v[210:211], v249 offset:1312
    s_waitcnt lgkmcnt(10)
    v_mfma_f32_32x32x16_bf16 v[64:79], v[228:231], v[108:111], v[64:79]
    s_waitcnt vmcnt(8)
    s_cmp_gt_u32 s6, 1
    s_cbranch_scc1 L_ld1
    s_waitcnt vmcnt(0)
L_ld1:
    s_waitcnt lgkmcnt(8)
    v_mfma_f32_32x32x16_bf16 v[0:15], v[192:195], v[112:115], v[0:15]
    ds_read_b64_tr_b16 v[212:213], v249 offset:5120
    ds_read_b64_tr_b16 v[214:215], v249 offset:6400
    ds_read_b64_tr_b16 v[216:217], v249 offset:5128
    s_waitcnt lgkmcnt(9)
    v_mfma_f32_32x32x16_bf16 v[16:31], v[196:199], v[112:115], v[16:31]
    ds_read_b64_tr_b16 v[218:219], v249 offset:6408
    ds_read_b64_tr_b16 v[220:221], v249 offset:5136
    ds_read_b64_tr_b16 v[222:223], v249 offset:6416
    s_cmp_eq_u32 s6, 2
    s_cselect_b32 s51, 8, 0
    s_and_b32 s51, s51, s4
    s_and_b32 s51, s51, s5
    s_cbranch_scc0 L_t6
    s_ff1_i32_b32 s7, s51
    s_bitset0_b32 s4, s7
    s_mov_b32 s6, 3
    s_add_u32 s51, s99, s7
    s_and_b32 s51, s51, 3
    s_sub_u32 s51, s51, s99
    s_lshl_b32 s51, s51, 16
    s_add_u32 s51, s51, 32768
    s_add_u32 s52, s51, s59
    s_add_u32 s53, s51, s60
    buffer_load_dwordx4 v[80:83], v248, s[40:43], s52 offen offset:0 sc1
    buffer_load_dwordx4 v[84:87], v248, s[40:43], s52 offen offset:1024 sc1
    buffer_load_dwordx4 v[88:91], v248, s[40:43], s52 offen offset:2048 sc1
    buffer_load_dwordx4 v[92:95], v248, s[40:43], s52 offen offset:3072 sc1
    buffer_load_dwordx4 v[96:99], v248, s[40:43], s53 offen offset:0 sc1
    buffer_load_dwordx4 v[100:103], v248, s[40:43], s53 offen offset:1024 sc1
    buffer_load_dwordx4 v[104:107], v248, s[40:43], s53 offen offset:2048 sc1
    buffer_load_dwordx4 v[108:111], v248, s[40:43], s53 offen offset:3072 sc1
L_t6:
    s_waitcnt lgkmcnt(10)
    v_mfma_f32_32x32x16_bf16 v[32:47], v[200:203], v[112:115], v[32:47]
    ds_read_b64_tr_b16 v[224:225], v249 offset:5144
    ds_read_b64_tr_b16 v[226:227], v249 offset:6424
    ds_read_b64_tr_b16 v[228:229], v249 offset:5152
    s_waitcnt lgkmcnt(11)
    v_mfma_f32_32x32x16_bf16 v[48:63], v[204:207], v[112:115], v[48:63]
    ds_read_b64_tr_b16 v[230:231], v249 offset:6432
    s_waitcnt lgkmcnt(10)
    v_mfma_f32_32x32x16_bf16 v[64:79], v[208:211], v[112:115], v[64:79]
    s_waitcnt lgkmcnt(8)
    v_mfma_f32_32x32x16_bf16 v[0:15], v[212:215], v[116:119], v[0:15]
    ds_read_b64_tr_b16 v[192:193], v249 offset:10240
    ds_read_b64_tr_b16 v[194:195], v249 offset:11520
    ds_read_b64_tr_b16 v[196:197], v249 offset:10248
    s_waitcnt lgkmcnt(9)
    v_mfma_f32_32x32x16_bf16 v[16:31], v[216:219], v[116:119], v[16:31]
    ds_read_b64_tr_b16 v[198:199], v249 offset:11528
    ds_read_b64_tr_b16 v[200:201], v249 offset:10256
    ds_read_b64_tr_b16 v[202:203], v249 offset:11536
    s_waitcnt lgkmcnt(10)
    v_mfma_f32_32x32x16_bf16 v[32:47], v[220:223], v[116:119], v[32:47]
    ds_read_b64_tr_b16 v[204:205], v249 offset:10264
    ds_read_b64_tr_b16 v[206:207], v249 offset:11544
    ds_read_b64_tr_b16 v[208:209], v249 offset:10272
    s_waitcnt lgkmcnt(11)
    v_mfma_f32_32x32x16_bf16 v[48:63], v[224:227], v[116:119], v[48:63]
    ds_read_b64_tr_b16 v[210:211], v249 offset:11552
    s_waitcnt lgkmcnt(10)
    v_mfma_f32_32x32x16_bf16 v[64:79], v[228:231], v[116:119], v[64:79]
    s_waitcnt lgkmcnt(8)
    v_mfma_f32_32x32x16_bf16 v[0:15], v[192:195], v[120:123], v[0:15]
    ds_read_b64_tr_b16 v[212:213], v249 offset:15360
    ds_read_b64_tr_b16 v[214:215], v249 offset:16640
    ds_read_b64_tr_b16 v[216:217], v249 offset:15368
    buffer_load_dword v145, v233, s[40:43], s45 offen offset:512 sc1
    s_waitcnt lgkmcnt(9)
    v_mfma_f32_32x32x16_bf16 v[16:31], v[196:199], v[120:123], v[16:31]
    ds_read_b64_tr_b16 v[218:219], v249 offset:16648
    ds_read_b64_tr_b16 v[220:221], v249 offset:15376
    ds_read_b64_tr_b16 v[222:223], v249 offset:16656
    s_waitcnt lgkmcnt(10)
    v_mfma_f32_32x32x16_bf16 v[32:47], v[200:203], v[120:123], v[32:47]
    ds_read_b64_tr_b16 v[224:225], v249 offset:15384
    ds_read_b64_tr_b16 v[226:227], v249 offset:16664
    ds_read_b64_tr_b16 v[228:229], v249 offset:15392
    s_waitcnt lgkmcnt(11)
    v_mfma_f32_32x32x16_bf16 v[48:63], v[204:207], v[120:123], v[48:63]
    ds_read_b64_tr_b16 v[230:231], v249 offset:16672
    s_waitcnt lgkmcnt(10)
    v_mfma_f32_32x32x16_bf16 v[64:79], v[208:211], v[120:123], v[64:79]
    s_waitcnt lgkmcnt(8)
    v_mfma_f32_32x32x16_bf16 v[0:15], v[212:215], v[124:127], v[0:15]
    ds_read_b64_tr_b16 v[192:193], v249 offset:20480
    ds_read_b64_tr_b16 v[194:195], v249 offset:21760
    ds_read_b64_tr_b16 v[196:197], v249 offset:20488
    s_waitcnt lgkmcnt(9)
    v_mfma_f32_32x32x16_bf16 v[16:31], v[216:219], v[124:127], v[16:31]
    ds_read_b64_tr_b16 v[198:199], v249 offset:21768
    ds_read_b64_tr_b16 v[200:201], v249 offset:20496
    ds_read_b64_tr_b16 v[202:203], v249 offset:21776
    s_waitcnt lgkmcnt(10)
    v_mfma_f32_32x32x16_bf16 v[32:47], v[220:223], v[124:127], v[32:47]
    ds_read_b64_tr_b16 v[204:205], v249 offset:20504
    ds_read_b64_tr_b16 v[206:207], v249 offset:21784
    ds_read_b64_tr_b16 v[208:209], v249 offset:20512
    s_waitcnt lgkmcnt(11)
    v_mfma_f32_32x32x16_bf16 v[48:63], v[224:227], v[124:127], v[48:63]
    ds_read_b64_tr_b16 v[210:211], v249 offset:21792
    s_waitcnt lgkmcnt(10)
    v_mfma_f32_32x32x16_bf16 v[64:79], v[228:231], v[124:127], v[64:79]
    s_waitcnt lgkmcnt(8)
    v_mfma_f32_32x32x16_bf16 v[0:15], v[192:195], v[128:131], v[0:15]
    ds_read_b64_tr_b16 v[212:213], v249 offset:25600
    ds_read_b64_tr_b16 v[214:215], v249 offset:26880
    ds_read_b64_tr_b16 v[216:217], v249 offset:25608
    s_waitcnt lgkmcnt(9)
    v_mfma_f32_32x32x16_bf16 v[16:31], v[196:199], v[128:131], v[16:31]
    ds_read_b64_tr_b16 v[218:219], v249 offset:26888
    ds_read_b64_tr_b16 v[220:221], v249 offset:25616
    ds_read_b64_tr_b16 v[222:223], v249 offset:26896
    s_waitcnt lgkmcnt(10)
    v_mfma_f32_32x32x16_bf16 v[32:47], v[200:203], v[128:131], v[32:47]
    ds_read_b64_tr_b16 v[224:225], v249 offset:25624
    ds_read_b64_tr_b16 v[226:227], v249 offset:26904
    ds_read_b64_tr_b16 v[228:229], v249 offset:25632
    s_waitcnt lgkmcnt(11)
    v_mfma_f32_32x32x16_bf16 v[48:63], v[204:207], v[128:131], v[48:63]
    ds_read_b64_tr_b16 v[230:231], v249 offset:26912
    s_waitcnt lgkmcnt(10)
    v_mfma_f32_32x32x16_bf16 v[64:79], v[208:211], v[128:131], v[64:79]
    s_waitcnt lgkmcnt(8)
    v_mfma_f32_32x32x16_bf16 v[0:15], v[212:215], v[132:135], v[0:15]
    ds_read_b64_tr_b16 v[192:193], v249 offset:30720
    ds_read_b64_tr_b16 v[194:195], v249 offset:32000
    ds_read_b64_tr_b16 v[196:197], v249 offset:30728
    s_waitcnt lgkmcnt(9)
    v_mfma_f32_32x32x16_bf16 v[16:31], v[216:219], v[132:135], v[16:31]
    ds_read_b64_tr_b16 v[198:199], v249 offset:32008
    ds_read_b64_tr_b16 v[200:201], v249 offset:30736
    ds_read_b64_tr_b16 v[202:203], v249 offset:32016
    s_waitcnt lgkmcnt(10)
    v_mfma_f32_32x32x16_bf16 v[32:47], v[220:223], v[132:135], v[32:47]
    ds_read_b64_tr_b16 v[204:205], v249 offset:30744
    ds_read_b64_tr_b16 v[206:207], v249 offset:32024
    ds_read_b64_tr_b16 v[208:209], v249 offset:30752
    s_waitcnt lgkmcnt(11)
    v_mfma_f32_32x32x16_bf16 v[48:63], v[224:227], v[132:135], v[48:63]
    ds_read_b64_tr_b16 v[210:211], v249 offset:32032
    s_waitcnt lgkmcnt(10)
    v_mfma_f32_32x32x16_bf16 v[64:79], v[228:231], v[132:135], v[64:79]
    s_waitcnt lgkmcnt(8)
    v_mfma_f32_32x32x16_bf16 v[0:15], v[192:195], v[136:139], v[0:15]
    ds_read_b64_tr_b16 v[212:213], v249 offset:35840
    ds_read_b64_tr_b16 v[214:215], v249 offset:37120
    ds_read_b64_tr_b16 v[216:217], v249 offset:35848
    s_waitcnt lgkmcnt(9)
    v_mfma_f32_32x32x16_bf16 v[16:31], v[196:199], v[136:139], v[16:31]
    ds_read_b64_tr_b16 v[218:219], v249 offset:37128
    ds_read_b64_tr_b16 v[220:221], v249 offset:35856
    ds_read_b64_tr_b16 v[222:223], v249 offset:37136
    s_waitcnt lgkmcnt(10)
    v_mfma_f32_32x32x16_bf16 v[32:47], v[200:203], v[136:139], v[32:47]
    ds_read_b64_tr_b16 v[224:225], v249 offset:35864
    ds_read_b64_tr_b16 v[226:227], v249 offset:37144
    ds_read_b64_tr_b16 v[228:229], v249 offset:35872
    s_waitcnt lgkmcnt(11)
    v_mfma_f32_32x32x16_bf16 v[48:63], v[204:207], v[136:139], v[48:63]
    ds_read_b64_tr_b16 v[230:231], v249 offset:37152
    s_waitcnt lgkmcnt(10)
    v_mfma_f32_32x32x16_bf16 v[64:79], v[208:211], v[136:139], v[64:79]
    s_cmp_eq_u32 s4, 0
    s_cbranch_scc1 L_nd2
    s_mov_b32 s61, 0x40000
L_nl2:
    s_waitcnt vmcnt(0)
    v_cmp_eq_u32 vcc, s100, v145
    s_nop 0
    s_mov_b32 s5, vcc_lo
    s_cmp_eq_u32 s6, 1
    s_cselect_b32 s51, 4, 0
    s_and_b32 s51, s51, s4
    s_and_b32 s51, s51, s5
    s_cbranch_scc0 L_t7
    s_ff1_i32_b32 s7, s51
    s_bitset0_b32 s4, s7
    s_mov_b32 s6, 2
    s_add_u32 s51, s99, s7
    s_and_b32 s51, s51, 3
    s_sub_u32 s51, s51, s99
    s_lshl_b32 s51, s51, 16
    s_add_u32 s51, s51, 32768
    s_add_u32 s52, s51, s59
    s_add_u32 s53, s51, s60
    buffer_load_dwordx4 v[160:163], v248, s[40:43], s52 offen offset:0 sc1
    buffer_load_dwordx4 v[164:167], v248, s[40:43], s52 offen offset:1024 sc1
    buffer_load_dwordx4 v[168:171], v248, s[40:43], s52 offen offset:2048 sc1
    buffer_load_dwordx4 v[172:175], v248, s[40:43], s52 offen offset:3072 sc1
    buffer_load_dwordx4 v[176:179], v248, s[40:43], s53 offen offset:0 sc1
    buffer_load_dwordx4 v[180:183], v248, s[40:43], s53 offen offset:1024 sc1
    buffer_load_dwordx4 v[184:187], v248, s[40:43], s53 offen offset:2048 sc1
    buffer_load_dwordx4 v[188:191], v248, s[40:43], s53 offen offset:3072 sc1
L_t7:
    s_cmp_eq_u32 s6, 2
    s_cselect_b32 s51, 8, 0
    s_and_b32 s51, s51, s4
    s_and_b32 s51, s51, s5
    s_cbranch_scc0 L_t8
    s_ff1_i32_b32 s7, s51
    s_bitset0_b32 s4, s7
    s_mov_b32 s6, 3
    s_add_u32 s51, s99, s7
    s_and_b32 s51, s51, 3
    s_sub_u32 s51, s51, s99
    s_lshl_b32 s51, s51, 16
    s_add_u32 s51, s51, 32768
    s_add_u32 s52, s51, s59
    s_add_u32 s53, s51, s60
    buffer_load_dwordx4 v[80:83], v248, s[40:43], s52 offen offset:0 sc1
    buffer_load_dwordx4 v[84:87], v248, s[40:43], s52 offen offset:1024 sc1
    buffer_load_dwordx4 v[88:91], v248, s[40:43], s52 offen offset:2048 sc1
    buffer_load_dwordx4 v[92:95], v248, s[40:43], s52 offen offset:3072 sc1
    buffer_load_dwordx4 v[96:99], v248, s[40:43], s53 offen offset:0 sc1
    buffer_load_dwordx4 v[100:103], v248, s[40:43], s53 offen offset:1024 sc1
    buffer_load_dwordx4 v[104:107], v248, s[40:43], s53 offen offset:2048 sc1
    buffer_load_dwordx4 v[108:111], v248, s[40:43], s53 offen offset:3072 sc1
L_t8:
    s_cmp_ge_u32 s6, 2
    s_cbranch_scc1 L_nd2
    buffer_load_dword v145, v233, s[40:43], s45 offen offset:512 sc1
    s_sub_u32 s61, s61, 1
    s_cmp_lg_u32 s61, 0
    s_cbranch_scc1 L_nl2
L_nd2:
    s_waitcnt lgkmcnt(8)
    v_mfma_f32_32x32x16_bf16 v[0:15], v[212:215], v[140:143], v[0:15]
    ds_read_b64_tr_b16 v[192:193], v235 offset:0
    ds_read_b64_tr_b16 v[194:195], v235 offset:1280
    ds_read_b64_tr_b16 v[196:197], v235 offset:8
    s_waitcnt lgkmcnt(9)
    v_mfma_f32_32x32x16_bf16 v[16:31], v[216:219], v[140:143], v[16:31]
    ds_read_b64_tr_b16 v[198:199], v235 offset:1288
    ds_read_b64_tr_b16 v[200:201], v235 offset:16
    ds_read_b64_tr_b16 v[202:203], v235 offset:1296
    s_waitcnt lgkmcnt(10)
    v_mfma_f32_32x32x16_bf16 v[32:47], v[220:223], v[140:143], v[32:47]
    ds_read_b64_tr_b16 v[204:205], v235 offset:24
    ds_read_b64_tr_b16 v[206:207], v235 offset:1304
    ds_read_b64_tr_b16 v[208:209], v235 offset:32
    s_waitcnt lgkmcnt(11)
    v_mfma_f32_32x32x16_bf16 v[48:63], v[224:227], v[140:143], v[48:63]
    ds_read_b64_tr_b16 v[210:211], v235 offset:1312
    s_waitcnt lgkmcnt(10)
    v_mfma_f32_32x32x16_bf16 v[64:79], v[228:231], v[140:143], v[64:79]
    s_waitcnt vmcnt(8)
    s_cmp_gt_u32 s6, 2
    s_cbranch_scc1 L_ld2
    s_waitcnt vmcnt(0)
L_ld2:
    s_waitcnt lgkmcnt(8)
    v_mfma_f32_32x32x16_bf16 v[0:15], v[192:195], v[160:163], v[0:15]
    ds_read_b64_tr_b16 v[212:213], v235 offset:5120
    ds_read_b64_tr_b16 v[214:215], v235 offset:6400
    ds_read_b64_tr_b16 v[216:217], v235 offset:5128
    s_waitcnt lgkmcnt(9)
    v_mfma_f32_32x32x16_bf16 v[16:31], v[196:199], v[160:163], v[16:31]
    ds_read_b64_tr_b16 v[218:219], v235 offset:6408
    ds_read_b64_tr_b16 v[220:221], v235 offset:5136
    ds_read_b64_tr_b16 v[222:223], v235 offset:6416
    s_waitcnt lgkmcnt(10)
    v_mfma_f32_32x32x16_bf16 v[32:47], v[200:203], v[160:163], v[32:47]
    ds_read_b64_tr_b16 v[224:225], v235 offset:5144
    ds_read_b64_tr_b16 v[226:227], v235 offset:6424
    ds_read_b64_tr_b16 v[228:229], v235 offset:5152
    s_waitcnt lgkmcnt(11)
    v_mfma_f32_32x32x16_bf16 v[48:63], v[204:207], v[160:163], v[48:63]
    ds_read_b64_tr_b16 v[230:231], v235 offset:6432
    s_waitcnt lgkmcnt(10)
    v_mfma_f32_32x32x16_bf16 v[64:79], v[208:211], v[160:163], v[64:79]
    s_waitcnt lgkmcnt(8)
    v_mfma_f32_32x32x16_bf16 v[0:15], v[212:215], v[164:167], v[0:15]
    ds_read_b64_tr_b16 v[192:193], v235 offset:10240
    ds_read_b64_tr_b16 v[194:195], v235 offset:11520
    ds_read_b64_tr_b16 v[196:197], v235 offset:10248
    s_waitcnt lgkmcnt(9)
    v_mfma_f32_32x32x16_bf16 v[16:31], v[216:219], v[164:167], v[16:31]
    ds_read_b64_tr_b16 v[198:199], v235 offset:11528
    ds_read_b64_tr_b16 v[200:201], v235 offset:10256
    ds_read_b64_tr_b16 v[202:203], v235 offset:11536
    s_waitcnt lgkmcnt(10)
    v_mfma_f32_32x32x16_bf16 v[32:47], v[220:223], v[164:167], v[32:47]
    ds_read_b64_tr_b16 v[204:205], v235 offset:10264
    ds_read_b64_tr_b16 v[206:207], v235 offset:11544
    ds_read_b64_tr_b16 v[208:209], v235 offset:10272
    s_waitcnt lgkmcnt(11)
    v_mfma_f32_32x32x16_bf16 v[48:63], v[224:227], v[164:167], v[48:63]
    ds_read_b64_tr_b16 v[210:211], v235 offset:11552
    s_waitcnt lgkmcnt(10)
    v_mfma_f32_32x32x16_bf16 v[64:79], v[228:231], v[164:167], v[64:79]
    s_waitcnt lgkmcnt(8)
    v_mfma_f32_32x32x16_bf16 v[0:15], v[192:195], v[168:171], v[0:15]
    ds_read_b64_tr_b16 v[212:213], v235 offset:15360
    ds_read_b64_tr_b16 v[214:215], v235 offset:16640
    ds_read_b64_tr_b16 v[216:217], v235 offset:15368
    buffer_load_dword v145, v233, s[40:43], s45 offen offset:512 sc1
    s_waitcnt lgkmcnt(9)
    v_mfma_f32_32x32x16_bf16 v[16:31], v[196:199], v[168:171], v[16:31]
    ds_read_b64_tr_b16 v[218:219], v235 offset:16648
    ds_read_b64_tr_b16 v[220:221], v235 offset:15376
    ds_read_b64_tr_b16 v[222:223], v235 offset:16656
    s_waitcnt lgkmcnt(10)
    v_mfma_f32_32x32x16_bf16 v[32:47], v[200:203], v[168:171], v[32:47]
    ds_read_b64_tr_b16 v[224:225], v235 offset:15384
    ds_read_b64_tr_b16 v[226:227], v235 offset:16664
    ds_read_b64_tr_b16 v[228:229], v235 offset:15392
    s_waitcnt lgkmcnt(11)
    v_mfma_f32_32x32x16_bf16 v[48:63], v[204:207], v[168:171], v[48:63]
    ds_read_b64_tr_b16 v[230:231], v235 offset:16672
    s_waitcnt lgkmcnt(10)
    v_mfma_f32_32x32x16_bf16 v[64:79], v[208:211], v[168:171], v[64:79]
    s_waitcnt lgkmcnt(8)
    v_mfma_f32_32x32x16_bf16 v[0:15], v[212:215], v[172:175], v[0:15]
    ds_read_b64_tr_b16 v[192:193], v235 offset:20480
    ds_read_b64_tr_b16 v[194:195], v235 offset:21760
    ds_read_b64_tr_b16 v[196:197], v235 offset:20488
    s_waitcnt lgkmcnt(9)
    v_mfma_f32_32x32x16_bf16 v[16:31], v[216:219], v[172:175], v[16:31]
    ds_read_b64_tr_b16 v[198:199], v235 offset:21768
    ds_read_b64_tr_b16 v[200:201], v235 offset:20496
    ds_read_b64_tr_b16 v[202:203], v235 offset:21776
    s_waitcnt lgkmcnt(10)
    v_mfma_f32_32x32x16_bf16 v[32:47], v[220:223], v[172:175], v[32:47]
    ds_read_b64_tr_b16 v[204:205], v235 offset:20504
    ds_read_b64_tr_b16 v[206:207], v235 offset:21784
    ds_read_b64_tr_b16 v[208:209], v235 offset:20512
    s_waitcnt lgkmcnt(11)
    v_mfma_f32_32x32x16_bf16 v[48:63], v[224:227], v[172:175], v[48:63]
    ds_read_b64_tr_b16 v[210:211], v235 offset:21792
    s_waitcnt lgkmcnt(10)
    v_mfma_f32_32x32x16_bf16 v[64:79], v[228:231], v[172:175], v[64:79]
    s_waitcnt lgkmcnt(8)
    v_mfma_f32_32x32x16_bf16 v[0:15], v[192:195], v[176:179], v[0:15]
    ds_read_b64_tr_b16 v[212:213], v235 offset:25600
    ds_read_b64_tr_b16 v[214:215], v235 offset:26880
    ds_read_b64_tr_b16 v[216:217], v235 offset:25608
    s_waitcnt lgkmcnt(9)
    v_mfma_f32_32x32x16_bf16 v[16:31], v[196:199], v[176:179], v[16:31]
    ds_read_b64_tr_b16 v[218:219], v235 offset:26888
    ds_read_b64_tr_b16 v[220:221], v235 offset:25616
    ds_read_b64_tr_b16 v[222:223], v235 offset:26896
    s_waitcnt lgkmcnt(10)
    v_mfma_f32_32x32x16_bf16 v[32:47], v[200:203], v[176:179], v[32:47]
    ds_read_b64_tr_b16 v[224:225], v235 offset:25624
    ds_read_b64_tr_b16 v[226:227], v235 offset:26904
    ds_read_b64_tr_b16 v[228:229], v235 offset:25632
    s_waitcnt lgkmcnt(11)
    v_mfma_f32_32x32x16_bf16 v[48:63], v[204:207], v[176:179], v[48:63]
    ds_read_b64_tr_b16 v[230:231], v235 offset:26912
    s_waitcnt lgkmcnt(10)
    v_mfma_f32_32x32x16_bf16 v[64:79], v[208:211], v[176:179], v[64:79]
    s_waitcnt lgkmcnt(8)
    v_mfma_f32_32x32x16_bf16 v[0:15], v[212:215], v[180:183], v[0:15]
    ds_read_b64_tr_b16 v[192:193], v235 offset:30720
    ds_read_b64_tr_b16 v[194:195], v235 offset:32000
    ds_read_b64_tr_b16 v[196:197], v235 offset:30728
    s_waitcnt lgkmcnt(9)
    v_mfma_f32_32x32x16_bf16 v[16:31], v[216:219], v[180:183], v[16:31]
    ds_read_b64_tr_b16 v[198:199], v235 offset:32008
    ds_read_b64_tr_b16 v[200:201], v235 offset:30736
    ds_read_b64_tr_b16 v[202:203], v235 offset:32016
    s_waitcnt lgkmcnt(10)
    v_mfma_f32_32x32x16_bf16 v[32:47], v[220:223], v[180:183], v[32:47]
    ds_read_b64_tr_b16 v[204:205], v235 offset:30744
    ds_read_b64_tr_b16 v[206:207], v235 offset:32024
    ds_read_b64_tr_b16 v[208:209], v235 offset:30752
    s_waitcnt lgkmcnt(11)
    v_mfma_f32_32x32x16_bf16 v[48:63], v[224:227], v[180:183], v[48:63]
    ds_read_b64_tr_b16 v[210:211], v235 offset:32032
    s_waitcnt lgkmcnt(10)
    v_mfma_f32_32x32x16_bf16 v[64:79], v[228:231], v[180:183], v[64:79]
    s_waitcnt lgkmcnt(8)
    v_mfma_f32_32x32x16_bf16 v[0:15], v[192:195], v[184:187], v[0:15]
    ds_read_b64_tr_b16 v[212:213], v235 offset:35840
    ds_read_b64_tr_b16 v[214:215], v235 offset:37120
    ds_read_b64_tr_b16 v[216:217], v235 offset:35848
    s_waitcnt lgkmcnt(9)
    v_mfma_f32_32x32x16_bf16 v[16:31], v[196:199], v[184:187], v[16:31]
    ds_read_b64_tr_b16 v[218:219], v235 offset:37128
    ds_read_b64_tr_b16 v[220:221], v235 offset:35856
    ds_read_b64_tr_b16 v[222:223], v235 offset:37136
    s_waitcnt lgkmcnt(10)
    v_mfma_f32_32x32x16_bf16 v[32:47], v[200:203], v[184:187], v[32:47]
    ds_read_b64_tr_b16 v[224:225], v235 offset:35864
    ds_read_b64_tr_b16 v[226:227], v235 offset:37144
    ds_read_b64_tr_b16 v[228:229], v235 offset:35872
    s_waitcnt lgkmcnt(11)
    v_mfma_f32_32x32x16_bf16 v[48:63], v[204:207], v[184:187], v[48:63]
    ds_read_b64_tr_b16 v[230:231], v235 offset:37152
    s_waitcnt lgkmcnt(10)
    v_mfma_f32_32x32x16_bf16 v[64:79], v[208:211], v[184:187], v[64:79]
    s_barrier
    s_cmp_eq_u32 s4, 0
    s_cbranch_scc1 L_nd3
    s_mov_b32 s61, 0x40000
L_nl3:
    s_waitcnt vmcnt(0)
    v_cmp_eq_u32 vcc, s100, v145
    s_nop 0
    s_mov_b32 s5, vcc_lo
    s_cmp_eq_u32 s6, 2
    s_cselect_b32 s51, 8, 0
    s_and_b32 s51, s51, s4
    s_and_b32 s51, s51, s5
    s_cbranch_scc0 L_t9
    s_ff1_i32_b32 s7, s51
    s_bitset0_b32 s4, s7
    s_mov_b32 s6, 3
    s_add_u32 s51, s99, s7
    s_and_b32 s51, s51, 3
    s_sub_u32 s51, s51, s99
    s_lshl_b32 s51, s51, 16
    s_add_u32 s51, s51, 32768
    s_add_u32 s52, s51, s59
    s_add_u32 s53, s51, s60
    buffer_load_dwordx4 v[80:83], v248, s[40:43], s52 offen offset:0 sc1
    buffer_load_dwordx4 v[84:87], v248, s[40:43], s52 offen offset:1024 sc1
    buffer_load_dwordx4 v[88:91], v248, s[40:43], s52 offen offset:2048 sc1
    buffer_load_dwordx4 v[92:95], v248, s[40:43], s52 offen offset:3072 sc1
    buffer_load_dwordx4 v[96:99], v248, s[40:43], s53 offen offset:0 sc1
    buffer_load_dwordx4 v[100:103], v248, s[40:43], s53 offen offset:1024 sc1
    buffer_load_dwordx4 v[104:107], v248, s[40:43], s53 offen offset:2048 sc1
    buffer_load_dwordx4 v[108:111], v248, s[40:43], s53 offen offset:3072 sc1
L_t9:
    s_cmp_ge_u32 s6, 3
    s_cbranch_scc1 L_nd3
    buffer_load_dword v145, v233, s[40:43], s45 offen offset:512 sc1
    s_sub_u32 s61, s61, 1
    s_cmp_lg_u32 s61, 0
    s_cbranch_scc1 L_nl3
L_nd3:
    s_waitcnt lgkmcnt(8)
    v_mfma_f32_32x32x16_bf16 v[0:15], v[212:215], v[188:191], v[0:15]
    ds_read_b64_tr_b16 v[192:193], v250 offset:0
    ds_read_b64_tr_b16 v[194:195], v250 offset:1280
    ds_read_b64_tr_b16 v[196:197], v250 offset:5120
    s_waitcnt lgkmcnt(9)
    v_mfma_f32_32x32x16_bf16 v[16:31], v[216:219], v[188:191], v[16:31]
    ds_read_b64_tr_b16 v[198:199], v250 offset:6400
    ds_read_b64_tr_b16 v[200:201], v250 offset:10240
    ds_read_b64_tr_b16 v[202:203], v250 offset:11520
    s_waitcnt lgkmcnt(10)
    v_mfma_f32_32x32x16_bf16 v[32:47], v[220:223], v[188:191], v[32:47]
    ds_read_b64_tr_b16 v[204:205], v250 offset:15360
    ds_read_b64_tr_b16 v[206:207], v250 offset:16640
    ds_read_b64_tr_b16 v[208:209], v250 offset:20480
    s_waitcnt lgkmcnt(11)
    v_mfma_f32_32x32x16_bf16 v[48:63], v[224:227], v[188:191], v[48:63]
    ds_read_b64_tr_b16 v[210:211], v250 offset:21760
    s_waitcnt lgkmcnt(10)
    v_mfma_f32_32x32x16_bf16 v[64:79], v[228:231], v[188:191], v[64:79]
    s_waitcnt vmcnt(0)
    s_mov_b32 s4, 14
    s_waitcnt lgkmcnt(8)
    v_mfma_f32_32x32x16_bf16 v[0:15], v[192:195], v[80:83], v[0:15]
    ds_read_b64_tr_b16 v[212:213], v250 offset:25600
    ds_read_b64_tr_b16 v[214:215], v250 offset:26880
    s_waitcnt lgkmcnt(8)
    v_mfma_f32_32x32x16_bf16 v[0:15], v[196:199], v[84:87], v[0:15]
    ds_read_b64_tr_b16 v[216:217], v250 offset:30720
    ds_read_b64_tr_b16 v[218:219], v250 offset:32000
    s_waitcnt lgkmcnt(8)
    v_mfma_f32_32x32x16_bf16 v[0:15], v[200:203], v[88:91], v[0:15]
    ds_read_b64_tr_b16 v[220:221], v250 offset:35840
    ds_read_b64_tr_b16 v[222:223], v250 offset:37120
    s_waitcnt lgkmcnt(8)
    v_mfma_f32_32x32x16_bf16 v[0:15], v[204:207], v[92:95], v[0:15]
    ds_read_b64_tr_b16 v[224:225], v250 offset:8
    ds_read_b64_tr_b16 v[226:227], v250 offset:1288
    s_waitcnt lgkmcnt(8)
    v_mfma_f32_32x32x16_bf16 v[0:15], v[208:211], v[96:99], v[0:15]
    ds_read_b64_tr_b16 v[228:229], v250 offset:5128
    ds_read_b64_tr_b16 v[230:231], v250 offset:6408
    s_waitcnt lgkmcnt(8)
    v_mfma_f32_32x32x16_bf16 v[0:15], v[212:215], v[100:103], v[0:15]
    ds_read_b64_tr_b16 v[192:193], v250 offset:10248
    ds_read_b64_tr_b16 v[194:195], v250 offset:11528
    s_waitcnt lgkmcnt(8)
    v_mfma_f32_32x32x16_bf16 v[0:15], v[216:219], v[104:107], v[0:15]
    ds_read_b64_tr_b16 v[196:197], v250 offset:15368
    ds_read_b64_tr_b16 v[198:199], v250 offset:16648
    s_waitcnt lgkmcnt(8)
    v_mfma_f32_32x32x16_bf16 v[0:15], v[220:223], v[108:111], v[0:15]
    ds_read_b64_tr_b16 v[200:201], v250 offset:20488
    ds_read_b64_tr_b16 v[202:203], v250 offset:21768
    s_waitcnt lgkmcnt(8)
    v_mfma_f32_32x32x16_bf16 v[16:31], v[224:227], v[80:83], v[16:31]
    ds_read_b64_tr_b16 v[204:205], v250 offset:25608
    ds_read_b64_tr_b16 v[206:207], v250 offset:26888
    s_waitcnt lgkmcnt(8)
    v_mfma_f32_32x32x16_bf16 v[16:31], v[228:231], v[84:87], v[16:31]
    ds_read_b64_tr_b16 v[208:209], v250 offset:30728
    ds_read_b64_tr_b16 v[210:211], v250 offset:32008
    s_waitcnt lgkmcnt(8)
    v_mfma_f32_32x32x16_bf16 v[16:31], v[192:195], v[88:91], v[16:31]
    ds_read_b64_tr_b16 v[212:213], v250 offset:35848
    ds_read_b64_tr_b16 v[214:215], v250 offset:37128
    s_waitcnt lgkmcnt(8)
    v_mfma_f32_32x32x16_bf16 v[16:31], v[196:199], v[92:95], v[16:31]
    ds_read_b64_tr_b16 v[216:217], v250 offset:16
    ds_read_b64_tr_b16 v[218:219], v250 offset:1296
    v_cvt_pk_bf16_f32 v112, v4, v5
    v_cvt_pk_bf16_f32 v113, v6, v7
    s_waitcnt lgkmcnt(8)
    v_mfma_f32_32x32x16_bf16 v[16:31], v[200:203], v[96:99], v[16:31]
    ds_read_b64_tr_b16 v[220:221], v250 offset:5136
    ds_read_b64_tr_b16 v[222:223], v250 offset:6416
    v_cvt_pk_bf16_f32 v120, v8, v9
    v_cvt_pk_bf16_f32 v121, v10, v11
    s_waitcnt lgkmcnt(8)
    v_mfma_f32_32x32x16_bf16 v[16:31], v[204:207], v[100:103], v[16:31]
    ds_read_b64_tr_b16 v[224:225], v250 offset:10256
    ds_read_b64_tr_b16 v[226:227], v250 offset:11536
    v_cvt_pk_bf16_f32 v128, v12, v13
    v_cvt_pk_bf16_f32 v129, v14, v15
    s_waitcnt lgkmcnt(8)
    v_mfma_f32_32x32x16_bf16 v[16:31], v[208:211], v[104:107], v[16:31]
    ds_read_b64_tr_b16 v[228:229], v250 offset:15376
    ds_read_b64_tr_b16 v[230:231], v250 offset:16656
    s_waitcnt lgkmcnt(8)
    v_mfma_f32_32x32x16_bf16 v[16:31], v[212:215], v[108:111], v[16:31]
    ds_read_b64_tr_b16 v[192:193], v250 offset:20496
    ds_read_b64_tr_b16 v[194:195], v250 offset:21776
    s_waitcnt lgkmcnt(8)
    v_mfma_f32_32x32x16_bf16 v[32:47], v[216:219], v[80:83], v[32:47]
    ds_read_b64_tr_b16 v[196:197], v250 offset:25616
    ds_read_b64_tr_b16 v[198:199], v250 offset:26896
    s_waitcnt lgkmcnt(8)
    v_mfma_f32_32x32x16_bf16 v[32:47], v[220:223], v[84:87], v[32:47]
    ds_read_b64_tr_b16 v[200:201], v250 offset:30736
    ds_read_b64_tr_b16 v[202:203], v250 offset:32016
    s_waitcnt lgkmcnt(8)
    v_mfma_f32_32x32x16_bf16 v[32:47], v[224:227], v[88:91], v[32:47]
    ds_read_b64_tr_b16 v[204:205], v250 offset:35856
    ds_read_b64_tr_b16 v[206:207], v250 offset:37136
    s_waitcnt lgkmcnt(8)
    v_mfma_f32_32x32x16_bf16 v[32:47], v[228:231], v[92:95], v[32:47]
    ds_read_b64_tr_b16 v[208:209], v250 offset:24
    ds_read_b64_tr_b16 v[210:211], v250 offset:1304
    v_cvt_pk_bf16_f32 v114, v20, v21
    v_cvt_pk_bf16_f32 v115, v22, v23
    buffer_store_dwordx4 v[112:115], v248, s[40:43], s56 offen offset:0 sc1
    s_waitcnt lgkmcnt(8)
    v_mfma_f32_32x32x16_bf16 v[32:47], v[192:195], v[96:99], v[32:47]
    ds_read_b64_tr_b16 v[212:213], v250 offset:5144
    ds_read_b64_tr_b16 v[214:215], v250 offset:6424
    v_cvt_pk_bf16_f32 v122, v24, v25
    v_cvt_pk_bf16_f32 v123, v26, v27
    buffer_store_dwordx4 v[120:123], v248, s[40:43], s56 offen offset:2048 sc1
    s_waitcnt lgkmcnt(8)
    v_mfma_f32_32x32x16_bf16 v[32:47], v[196:199], v[100:103], v[32:47]
    ds_read_b64_tr_b16 v[216:217], v250 offset:10264
    ds_read_b64_tr_b16 v[218:219], v250 offset:11544
    v_cvt_pk_bf16_f32 v130, v28, v29
    v_cvt_pk_bf16_f32 v131, v30, v31
    buffer_store_dwordx4 v[128:131], v248, s[40:43], s55 offen offset:0 sc1
    s_waitcnt lgkmcnt(8)
    v_mfma_f32_32x32x16_bf16 v[32:47], v[200:203], v[104:107], v[32:47]
    ds_read_b64_tr_b16 v[220:221], v250 offset:15384
    ds_read_b64_tr_b16 v[222:223], v250 offset:16664
    s_waitcnt lgkmcnt(8)
    v_mfma_f32_32x32x16_bf16 v[32:47], v[204:207], v[108:111], v[32:47]
    ds_read_b64_tr_b16 v[224:225], v250 offset:20504
    ds_read_b64_tr_b16 v[226:227], v250 offset:21784
    s_waitcnt lgkmcnt(8)
    v_mfma_f32_32x32x16_bf16 v[48:63], v[208:211], v[80:83], v[48:63]
    ds_read_b64_tr_b16 v[228:229], v250 offset:25624
    ds_read_b64_tr_b16 v[230:231], v250 offset:26904
    s_waitcnt lgkmcnt(8)
    v_mfma_f32_32x32x16_bf16 v[48:63], v[212:215], v[84:87], v[48:63]
    ds_read_b64_tr_b16 v[192:193], v250 offset:30744
    ds_read_b64_tr_b16 v[194:195], v250 offset:32024
    s_waitcnt lgkmcnt(8)
    v_mfma_f32_32x32x16_bf16 v[48:63], v[216:219], v[88:91], v[48:63]
    ds_read_b64_tr_b16 v[196:197], v250 offset:35864
    ds_read_b64_tr_b16 v[198:199], v250 offset:37144
    s_waitcnt lgkmcnt(8)
    v_mfma_f32_32x32x16_bf16 v[48:63], v[220:223], v[92:95], v[48:63]
    ds_read_b64_tr_b16 v[200:201], v250 offset:32
    ds_read_b64_tr_b16 v[202:203], v250 offset:1312
    v_cvt_pk_bf16_f32 v116, v36, v37
    v_cvt_pk_bf16_f32 v117, v38, v39
    s_waitcnt lgkmcnt(8)
    v_mfma_f32_32x32x16_bf16 v[48:63], v[224:227], v[96:99], v[48:63]
    ds_read_b64_tr_b16 v[204:205], v250 offset:5152
    ds_read_b64_tr_b16 v[206:207], v250 offset:6432
    v_cvt_pk_bf16_f32 v124, v40, v41
    v_cvt_pk_bf16_f32 v125, v42, v43
    s_waitcnt lgkmcnt(8)
    v_mfma_f32_32x32x16_bf16 v[48:63], v[228:231], v[100:103], v[48:63]
    ds_read_b64_tr_b16 v[208:209], v250 offset:10272
    ds_read_b64_tr_b16 v[210:211], v250 offset:11552
    v_cvt_pk_bf16_f32 v132, v44, v45
    v_cvt_pk_bf16_f32 v133, v46, v47
    s_waitcnt lgkmcnt(8)
    v_mfma_f32_32x32x16_bf16 v[48:63], v[192:195], v[104:107], v[48:63]
    ds_read_b64_tr_b16 v[212:213], v250 offset:15392
    ds_read_b64_tr_b16 v[214:215], v250 offset:16672
    buffer_load_dword v145, v237, s[40:43], s46 offen sc1
    s_waitcnt lgkmcnt(8)
    v_mfma_f32_32x32x16_bf16 v[48:63], v[196:199], v[108:111], v[48:63]
    ds_read_b64_tr_b16 v[216:217], v250 offset:20512
    ds_read_b64_tr_b16 v[218:219], v250 offset:21792
    s_waitcnt lgkmcnt(8)
    v_mfma_f32_32x32x16_bf16 v[64:79], v[200:203], v[80:83], v[64:79]
    ds_read_b64_tr_b16 v[220:221], v250 offset:25632
    ds_read_b64_tr_b16 v[222:223], v250 offset:26912
    s_waitcnt lgkmcnt(8)
    v_mfma_f32_32x32x16_bf16 v[64:79], v[204:207], v[84:87], v[64:79]
    ds_read_b64_tr_b16 v[224:225], v250 offset:30752
    ds_read_b64_tr_b16 v[226:227], v250 offset:32032
    s_waitcnt lgkmcnt(8)
    v_mfma_f32_32x32x16_bf16 v[64:79], v[208:211], v[88:91], v[64:79]
    ds_read_b64_tr_b16 v[228:229], v250 offset:35872
    ds_read_b64_tr_b16 v[230:231], v250 offset:37152
    s_waitcnt lgkmcnt(8)
    v_mfma_f32_32x32x16_bf16 v[64:79], v[212:215], v[92:95], v[64:79]
    v_cvt_pk_bf16_f32 v118, v52, v53
    v_cvt_pk_bf16_f32 v119, v54, v55
    buffer_store_dwordx4 v[116:119], v248, s[40:43], s56 offen offset:1024 sc1
    s_waitcnt lgkmcnt(6)
    v_mfma_f32_32x32x16_bf16 v[64:79], v[216:219], v[96:99], v[64:79]
    v_cvt_pk_bf16_f32 v126, v56, v57
    v_cvt_pk_bf16_f32 v127, v58, v59
    buffer_store_dwordx4 v[124:127], v248, s[40:43], s56 offen offset:3072 sc1
    s_waitcnt lgkmcnt(4)
    v_mfma_f32_32x32x16_bf16 v[64:79], v[220:223], v[100:103], v[64:79]
    v_cvt_pk_bf16_f32 v134, v60, v61
    v_cvt_pk_bf16_f32 v135, v62, v63
    buffer_store_dwordx4 v[132:135], v248, s[40:43], s55 offen offset:1024 sc1
    s_waitcnt lgkmcnt(2)
    v_mfma_f32_32x32x16_bf16 v[64:79], v[224:227], v[104:107], v[64:79]
    s_waitcnt lgkmcnt(0)
    v_mfma_f32_32x32x16_bf16 v[64:79], v[228:231], v[108:111], v[64:79]
    s_nop 11
    v_cvt_pk_bf16_f32 v136, v68, v69
    v_cvt_pk_bf16_f32 v137, v70, v71
    v_cvt_pk_bf16_f32 v138, v72, v73
    v_cvt_pk_bf16_f32 v139, v74, v75
    v_cvt_pk_bf16_f32 v140, v76, v77
    v_cvt_pk_bf16_f32 v141, v78, v79
    v_permlane32_swap_b32 v136, v138
    v_permlane32_swap_b32 v137, v139
    v_permlane32_swap_b32 v140, v142
    v_permlane32_swap_b32 v141, v143
    buffer_store_dwordx4 v[136:139], v248, s[40:43], s55 offen offset:2048 sc1
    s_mov_b32 exec_hi, 0
    buffer_store_dwordx4 v[140:143], v248, s[40:43], s55 offen offset:3072 sc1
    s_mov_b64 exec, -1
    s_waitcnt vmcnt(0)
    s_mov_b64 exec, 1
    buffer_store_dword v144, off, s[40:43], s62 sc1
    s_mov_b64 exec, -1
    s_mov_b32 s61, 0x40000
L_gp:
    v_cmp_eq_u32 vcc, s100, v145
    s_nop 0
    s_and_b32 s5, vcc_lo, s4
    s_andn2_b32 s4, s4, s5
    s_bitcmp1_b32 s5, 1
    s_cbranch_scc0 L_sp1
    buffer_load_dwordx4 v[192:195], v248, s[40:43], s54 offen offset:0 sc1
    buffer_load_dwordx4 v[196:199], v248, s[40:43], s54 offen offset:1024 sc1
    buffer_load_dwordx2 v[200:201], v245, s[40:43], s54 offen offset:3072 sc1
L_sp1:
    s_bitcmp1_b32 s5, 2
    s_cbranch_scc0 L_sp2
    buffer_load_dwordx4 v[204:207], v248, s[40:43], s47 offen offset:0 sc1
    buffer_load_dwordx4 v[208:211], v248, s[40:43], s47 offen offset:1024 sc1
    buffer_load_dwordx2 v[212:213], v245, s[40:43], s47 offen offset:1536 sc1
L_sp2:
    s_bitcmp1_b32 s5, 3
    s_cbranch_scc0 L_sp3
    buffer_load_dwordx4 v[216:219], v248, s[40:43], s64 offen offset:0 sc1
    buffer_load_dwordx4 v[220:223], v248, s[40:43], s64 offen offset:1024 sc1
    buffer_load_dwordx2 v[224:225], v245, s[40:43], s64 offen offset:0 sc1
L_sp3:
    s_cmp_eq_u32 s4, 0
    s_cbranch_scc1 L_dp
    buffer_load_dword v145, v237, s[40:43], s46 offen sc1
    s_sub_u32 s61, s61, 1
    s_cmp_lg_u32 s61, 0
    s_waitcnt vmcnt(0)
    s_cbranch_scc1 L_gp
L_dp:
    s_mov_b32 s61, 0x40000
L_sum:
    s_waitcnt vmcnt(0)
    v_lshlrev_b32 v4, 16, v192
    v_and_b32 v5, 0xffff0000, v192
    v_lshlrev_b32 v6, 16, v193
    v_and_b32 v7, 0xffff0000, v193
    v_lshlrev_b32 v8, 16, v204
    v_and_b32 v9, 0xffff0000, v204
    v_lshlrev_b32 v10, 16, v205
    v_and_b32 v11, 0xffff0000, v205
    v_lshlrev_b32 v12, 16, v216
    v_and_b32 v13, 0xffff0000, v216
    v_lshlrev_b32 v14, 16, v217
    v_and_b32 v15, 0xffff0000, v217
    v_pk_add_f32 v[96:97], v[0:1], v[4:5]
    v_pk_add_f32 v[98:99], v[2:3], v[6:7]
    v_pk_add_f32 v[96:97], v[96:97], v[8:9]
    v_pk_add_f32 v[98:99], v[98:99], v[10:11]
    v_pk_add_f32 v[96:97], v[96:97], v[12:13]
    v_pk_add_f32 v[98:99], v[98:99], v[14:15]
    v_cvt_pk_bf16_f32 v80, v96, v97
    v_cvt_pk_bf16_f32 v81, v98, v99
    v_lshlrev_b32 v20, 16, v194
    v_and_b32 v21, 0xffff0000, v194
    v_lshlrev_b32 v22, 16, v195
    v_and_b32 v23, 0xffff0000, v195
    v_lshlrev_b32 v24, 16, v206
    v_and_b32 v25, 0xffff0000, v206
    v_lshlrev_b32 v26, 16, v207
    v_and_b32 v27, 0xffff0000, v207
    v_lshlrev_b32 v28, 16, v218
    v_and_b32 v29, 0xffff0000, v218
    v_lshlrev_b32 v30, 16, v219
    v_and_b32 v31, 0xffff0000, v219
    v_pk_add_f32 v[100:101], v[16:17], v[20:21]
    v_pk_add_f32 v[102:103], v[18:19], v[22:23]
    v_pk_add_f32 v[100:101], v[100:101], v[24:25]
    v_pk_add_f32 v[102:103], v[102:103], v[26:27]
    v_pk_add_f32 v[100:101], v[100:101], v[28:29]
    v_pk_add_f32 v[102:103], v[102:103], v[30:31]
    v_cvt_pk_bf16_f32 v82, v100, v101
    v_cvt_pk_bf16_f32 v83, v102, v103
    v_lshlrev_b32 v36, 16, v196
    v_and_b32 v37, 0xffff0000, v196
    v_lshlrev_b32 v38, 16, v197
    v_and_b32 v39, 0xffff0000, v197
    v_lshlrev_b32 v40, 16, v208
    v_and_b32 v41, 0xffff0000, v208
    v_lshlrev_b32 v42, 16, v209
    v_and_b32 v43, 0xffff0000, v209
    v_lshlrev_b32 v44, 16, v220
    v_and_b32 v45, 0xffff0000, v220
    v_lshlrev_b32 v46, 16, v221
    v_and_b32 v47, 0xffff0000, v221
    v_pk_add_f32 v[96:97], v[32:33], v[36:37]
    v_pk_add_f32 v[98:99], v[34:35], v[38:39]
    v_pk_add_f32 v[96:97], v[96:97], v[40:41]
    v_pk_add_f32 v[98:99], v[98:99], v[42:43]
    v_pk_add_f32 v[96:97], v[96:97], v[44:45]
    v_pk_add_f32 v[98:99], v[98:99], v[46:47]
    v_cvt_pk_bf16_f32 v84, v96, v97
    v_cvt_pk_bf16_f32 v85, v98, v99
    v_lshlrev_b32 v52, 16, v198
    v_and_b32 v53, 0xffff0000, v198
    v_lshlrev_b32 v54, 16, v199
    v_and_b32 v55, 0xffff0000, v199
    v_lshlrev_b32 v56, 16, v210
    v_and_b32 v57, 0xffff0000, v210
    v_lshlrev_b32 v58, 16, v211
    v_and_b32 v59, 0xffff0000, v211
    v_lshlrev_b32 v60, 16, v222
    v_and_b32 v61, 0xffff0000, v222
    v_lshlrev_b32 v62, 16, v223
    v_and_b32 v63, 0xffff0000, v223
    v_pk_add_f32 v[100:101], v[48:49], v[52:53]
    v_pk_add_f32 v[102:103], v[50:51], v[54:55]
    v_pk_add_f32 v[100:101], v[100:101], v[56:57]
    v_pk_add_f32 v[102:103], v[102:103], v[58:59]
    v_pk_add_f32 v[100:101], v[100:101], v[60:61]
    v_pk_add_f32 v[102:103], v[102:103], v[62:63]
    v_cvt_pk_bf16_f32 v86, v100, v101
    v_cvt_pk_bf16_f32 v87, v102, v103
    v_lshlrev_b32 v68, 16, v200
    v_and_b32 v69, 0xffff0000, v200
    v_lshlrev_b32 v70, 16, v201
    v_and_b32 v71, 0xffff0000, v201
    v_lshlrev_b32 v72, 16, v212
    v_and_b32 v73, 0xffff0000, v212
    v_lshlrev_b32 v74, 16, v213
    v_and_b32 v75, 0xffff0000, v213
    v_lshlrev_b32 v76, 16, v224
    v_and_b32 v77, 0xffff0000, v224
    v_lshlrev_b32 v78, 16, v225
    v_and_b32 v79, 0xffff0000, v225
    v_pk_add_f32 v[96:97], v[64:65], v[68:69]
    v_pk_add_f32 v[98:99], v[66:67], v[70:71]
    v_pk_add_f32 v[96:97], v[96:97], v[72:73]
    v_pk_add_f32 v[98:99], v[98:99], v[74:75]
    v_pk_add_f32 v[96:97], v[96:97], v[76:77]
    v_pk_add_f32 v[98:99], v[98:99], v[78:79]
    v_cvt_pk_bf16_f32 v88, v96, v97
    v_cvt_pk_bf16_f32 v89, v98, v99
    buffer_store_dwordx4 v[80:83], v236, s[20:23], s63 offen
    buffer_store_dwordx4 v[84:87], v236, s[20:23], s63 offen offset:16
    buffer_store_dwordx2 v[88:89], v236, s[20:23], s63 offen offset:32
    s_or_b32 s51, s48, s99
    s_or_b32 s51, s51, s98
    s_cmp_lg_u32 s51, 0
    s_cbranch_scc1 L_fin
    s_lshl_b32 s51, s49, 7
    s_add_u32 s51, s51, 42074112
    s_mov_b64 exec, 1
    buffer_store_dword v144, off, s[40:43], s51 sc1
    s_mov_b64 exec, -1
L_fin:
L_end:
    s_endpgm
L_fb0:
    s_mov_b32 s62, 0
    s_branch L_fbp1
L_fb21:
    s_mov_b32 s62, 21
    s_branch L_fbp0
L_fb22:
    s_mov_b32 s62, 22
    s_branch L_fbp1
L_fb23:
    s_mov_b32 s62, 23
    s_branch L_fbp0
L_fb20:
    s_mov_b32 s62, 20
    s_branch L_fbp1
L_fb9:
    s_mov_b32 s62, 9
    s_branch L_fbp0
L_fb10:
    s_mov_b32 s62, 10
    s_branch L_fbp1
L_fb11:
    s_mov_b32 s62, 11
    s_branch L_fbp0
L_fb12:
    s_mov_b32 s62, 12
    s_branch L_fbp1
L_fb13:
    s_mov_b32 s62, 13
    s_branch L_fbp0
L_fb14:
    s_mov_b32 s62, 14
    s_branch L_fbp1
L_fbp0:
    s_nop 15
    v_max3_f32 v244, v112, v113, v114
    v_max3_f32 v244, v244, v115, v116
    v_max3_f32 v244, v244, v117, v118
    v_max3_f32 v244, v244, v119, v120
    v_max3_f32 v244, v244, v121, v122
    v_max3_f32 v244, v244, v123, v124
    v_max3_f32 v244, v244, v125, v126
    v_max_f32 v244, v244, v127
    v_mov_b32 v245, v244
    s_nop 1
    v_permlane32_swap_b32 v244, v245
    v_max3_f32 v244, v244, v245, 0
    v_sub_f32 v245, 0, v244
    v_exp_f32 v245, v245
    v_sub_f32 v96, v96, v244
    v_sub_f32 v97, v97, v244
    v_sub_f32 v98, v98, v244
    v_sub_f32 v99, v99, v244
    v_sub_f32 v100, v100, v244
    v_sub_f32 v101, v101, v244
    v_sub_f32 v102, v102, v244
    v_sub_f32 v103, v103, v244
    v_sub_f32 v104, v104, v244
    v_sub_f32 v105, v105, v244
    v_sub_f32 v106, v106, v244
    v_sub_f32 v107, v107, v244
    v_sub_f32 v108, v108, v244
    v_sub_f32 v109, v109, v244
    v_sub_f32 v110, v110, v244
    v_sub_f32 v111, v111, v244
    v_mul_f32 v0, v0, v245
    v_mul_f32 v1, v1, v245
    v_mul_f32 v2, v2, v245
    v_mul_f32 v3, v3, v245
    v_mul_f32 v4, v4, v245
    v_mul_f32 v5, v5, v245
    v_mul_f32 v6, v6, v245
    v_mul_f32 v7, v7, v245
    v_mul_f32 v8, v8, v245
    v_mul_f32 v9, v9, v245
    v_mul_f32 v10, v10, v245
    v_mul_f32 v11, v11, v245
    v_mul_f32 v12, v12, v245
    v_mul_f32 v13, v13, v245
    v_mul_f32 v14, v14, v245
    v_mul_f32 v15, v15, v245
    v_mul_f32 v16, v16, v245
    v_mul_f32 v17, v17, v245
    v_mul_f32 v18, v18, v245
    v_mul_f32 v19, v19, v245
    v_mul_f32 v20, v20, v245
    v_mul_f32 v21, v21, v245
    v_mul_f32 v22, v22, v245
    v_mul_f32 v23, v23, v245
    v_mul_f32 v24, v24, v245
    v_mul_f32 v25, v25, v245
    v_mul_f32 v26, v26, v245
    v_mul_f32 v27, v27, v245
    v_mul_f32 v28, v28, v245
    v_mul_f32 v29, v29, v245
    v_mul_f32 v30, v30, v245
    v_mul_f32 v31, v31, v245
    v_mul_f32 v32, v32, v245
    v_mul_f32 v33, v33, v245
    v_mul_f32 v34, v34, v245
    v_mul_f32 v35, v35, v245
    v_mul_f32 v36, v36, v245
    v_mul_f32 v37, v37, v245
    v_mul_f32 v38, v38, v245
    v_mul_f32 v39, v39, v245
    v_mul_f32 v40, v40, v245
    v_mul_f32 v41, v41, v245
    v_mul_f32 v42, v42, v245
    v_mul_f32 v43, v43, v245
    v_mul_f32 v44, v44, v245
    v_mul_f32 v45, v45, v245
    v_mul_f32 v46, v46, v245
    v_mul_f32 v47, v47, v245
    v_mul_f32 v48, v48, v245
    v_mul_f32 v49, v49, v245
    v_mul_f32 v50, v50, v245
    v_mul_f32 v51, v51, v245
    v_mul_f32 v52, v52, v245
    v_mul_f32 v53, v53, v245
    v_mul_f32 v54, v54, v245
    v_mul_f32 v55, v55, v245
    v_mul_f32 v56, v56, v245
    v_mul_f32 v57, v57, v245
    v_mul_f32 v58, v58, v245
    v_mul_f32 v59, v59, v245
    v_mul_f32 v60, v60, v245
    v_mul_f32 v61, v61, v245
    v_mul_f32 v62, v62, v245
    v_mul_f32 v63, v63, v245
    v_mul_f32 v232, v232, v245
    v_sub_f32 v112, v112, v244
    v_sub_f32 v128, v128, v244
    v_sub_f32 v113, v113, v244
    v_sub_f32 v129, v129, v244
    v_sub_f32 v114, v114, v244
    v_sub_f32 v130, v130, v244
    v_sub_f32 v115, v115, v244
    v_sub_f32 v131, v131, v244
    v_sub_f32 v116, v116, v244
    v_sub_f32 v132, v132, v244
    v_sub_f32 v117, v117, v244
    v_sub_f32 v133, v133, v244
    v_sub_f32 v118, v118, v244
    v_sub_f32 v134, v134, v244
    v_sub_f32 v119, v119, v244
    v_sub_f32 v135, v135, v244
    v_sub_f32 v120, v120, v244
    v_sub_f32 v136, v136, v244
    v_sub_f32 v121, v121, v244
    v_sub_f32 v137, v137, v244
    v_sub_f32 v122, v122, v244
    v_sub_f32 v138, v138, v244
    v_sub_f32 v123, v123, v244
    v_sub_f32 v139, v139, v244
    v_sub_f32 v124, v124, v244
    v_sub_f32 v140, v140, v244
    v_sub_f32 v125, v125, v244
    v_sub_f32 v141, v141, v244
    v_sub_f32 v126, v126, v244
    v_sub_f32 v142, v142, v244
    v_sub_f32 v127, v127, v244
    v_sub_f32 v143, v143, v244
    v_mov_b32 v233, 0
    v_exp_f32 v224, v112
    v_exp_f32 v225, v113
    s_nop 0
    v_add_f32 v233, v233, v224
    v_add_f32 v233, v233, v225
    v_cvt_pk_bf16_f32 v144, v224, v225
    v_exp_f32 v224, v114
    v_exp_f32 v225, v115
    s_nop 0
    v_add_f32 v233, v233, v224
    v_add_f32 v233, v233, v225
    v_cvt_pk_bf16_f32 v145, v224, v225
    v_exp_f32 v224, v116
    v_exp_f32 v225, v117
    s_nop 0
    v_add_f32 v233, v233, v224
    v_add_f32 v233, v233, v225
    v_cvt_pk_bf16_f32 v146, v224, v225
    v_exp_f32 v224, v118
    v_exp_f32 v225, v119
    s_nop 0
    v_add_f32 v233, v233, v224
    v_add_f32 v233, v233, v225
    v_cvt_pk_bf16_f32 v147, v224, v225
    v_exp_f32 v224, v120
    v_exp_f32 v225, v121
    s_nop 0
    v_add_f32 v233, v233, v224
    v_add_f32 v233, v233, v225
    v_cvt_pk_bf16_f32 v148, v224, v225
    v_exp_f32 v224, v122
    v_exp_f32 v225, v123
    s_nop 0
    v_add_f32 v233, v233, v224
    v_add_f32 v233, v233, v225
    v_cvt_pk_bf16_f32 v149, v224, v225
    v_exp_f32 v224, v124
    v_exp_f32 v225, v125
    s_nop 0
    v_add_f32 v233, v233, v224
    v_add_f32 v233, v233, v225
    v_cvt_pk_bf16_f32 v150, v224, v225
    v_exp_f32 v224, v126
    v_exp_f32 v225, v127
    s_nop 0
    v_add_f32 v233, v233, v224
    v_add_f32 v233, v233, v225
    v_cvt_pk_bf16_f32 v151, v224, v225
    s_nop 3
    s_cmp_eq_u32 s62, 21
    s_cbranch_scc1 L_ret21
    s_cmp_eq_u32 s62, 23
    s_cbranch_scc1 L_ret23
    s_cmp_eq_u32 s62, 9
    s_cbranch_scc1 L_ret9
    s_cmp_eq_u32 s62, 11
    s_cbranch_scc1 L_ret11
    s_branch L_ret13

L_fbp1:
    s_nop 15
    v_max3_f32 v244, v128, v129, v130
    v_max3_f32 v244, v244, v131, v132
    v_max3_f32 v244, v244, v133, v134
    v_max3_f32 v244, v244, v135, v136
    v_max3_f32 v244, v244, v137, v138
    v_max3_f32 v244, v244, v139, v140
    v_max3_f32 v244, v244, v141, v142
    v_max_f32 v244, v244, v143
    v_mov_b32 v245, v244
    s_nop 1
    v_permlane32_swap_b32 v244, v245
    v_max3_f32 v244, v244, v245, 0
    v_sub_f32 v245, 0, v244
    v_exp_f32 v245, v245
    v_sub_f32 v96, v96, v244
    v_sub_f32 v97, v97, v244
    v_sub_f32 v98, v98, v244
    v_sub_f32 v99, v99, v244
    v_sub_f32 v100, v100, v244
    v_sub_f32 v101, v101, v244
    v_sub_f32 v102, v102, v244
    v_sub_f32 v103, v103, v244
    v_sub_f32 v104, v104, v244
    v_sub_f32 v105, v105, v244
    v_sub_f32 v106, v106, v244
    v_sub_f32 v107, v107, v244
    v_sub_f32 v108, v108, v244
    v_sub_f32 v109, v109, v244
    v_sub_f32 v110, v110, v244
    v_sub_f32 v111, v111, v244
    v_mul_f32 v0, v0, v245
    v_mul_f32 v1, v1, v245
    v_mul_f32 v2, v2, v245
    v_mul_f32 v3, v3, v245
    v_mul_f32 v4, v4, v245
    v_mul_f32 v5, v5, v245
    v_mul_f32 v6, v6, v245
    v_mul_f32 v7, v7, v245
    v_mul_f32 v8, v8, v245
    v_mul_f32 v9, v9, v245
    v_mul_f32 v10, v10, v245
    v_mul_f32 v11, v11, v245
    v_mul_f32 v12, v12, v245
    v_mul_f32 v13, v13, v245
    v_mul_f32 v14, v14, v245
    v_mul_f32 v15, v15, v245
    v_mul_f32 v16, v16, v245
    v_mul_f32 v17, v17, v245
    v_mul_f32 v18, v18, v245
    v_mul_f32 v19, v19, v245
    v_mul_f32 v20, v20, v245
    v_mul_f32 v21, v21, v245
    v_mul_f32 v22, v22, v245
    v_mul_f32 v23, v23, v245
    v_mul_f32 v24, v24, v245
    v_mul_f32 v25, v25, v245
    v_mul_f32 v26, v26, v245
    v_mul_f32 v27, v27, v245
    v_mul_f32 v28, v28, v245
    v_mul_f32 v29, v29, v245
    v_mul_f32 v30, v30, v245
    v_mul_f32 v31, v31, v245
    v_mul_f32 v32, v32, v245
    v_mul_f32 v33, v33, v245
    v_mul_f32 v34, v34, v245
    v_mul_f32 v35, v35, v245
    v_mul_f32 v36, v36, v245
    v_mul_f32 v37, v37, v245
    v_mul_f32 v38, v38, v245
    v_mul_f32 v39, v39, v245
    v_mul_f32 v40, v40, v245
    v_mul_f32 v41, v41, v245
    v_mul_f32 v42, v42, v245
    v_mul_f32 v43, v43, v245
    v_mul_f32 v44, v44, v245
    v_mul_f32 v45, v45, v245
    v_mul_f32 v46, v46, v245
    v_mul_f32 v47, v47, v245
    v_mul_f32 v48, v48, v245
    v_mul_f32 v49, v49, v245
    v_mul_f32 v50, v50, v245
    v_mul_f32 v51, v51, v245
    v_mul_f32 v52, v52, v245
    v_mul_f32 v53, v53, v245
    v_mul_f32 v54, v54, v245
    v_mul_f32 v55, v55, v245
    v_mul_f32 v56, v56, v245
    v_mul_f32 v57, v57, v245
    v_mul_f32 v58, v58, v245
    v_mul_f32 v59, v59, v245
    v_mul_f32 v60, v60, v245
    v_mul_f32 v61, v61, v245
    v_mul_f32 v62, v62, v245
    v_mul_f32 v63, v63, v245
    v_mul_f32 v232, v232, v245
    v_sub_f32 v128, v128, v244
    v_sub_f32 v112, v112, v244
    v_sub_f32 v129, v129, v244
    v_sub_f32 v113, v113, v244
    v_sub_f32 v130, v130, v244
    v_sub_f32 v114, v114, v244
    v_sub_f32 v131, v131, v244
    v_sub_f32 v115, v115, v244
    v_sub_f32 v132, v132, v244
    v_sub_f32 v116, v116, v244
    v_sub_f32 v133, v133, v244
    v_sub_f32 v117, v117, v244
    v_sub_f32 v134, v134, v244
    v_sub_f32 v118, v118, v244
    v_sub_f32 v135, v135, v244
    v_sub_f32 v119, v119, v244
    v_sub_f32 v136, v136, v244
    v_sub_f32 v120, v120, v244
    v_sub_f32 v137, v137, v244
    v_sub_f32 v121, v121, v244
    v_sub_f32 v138, v138, v244
    v_sub_f32 v122, v122, v244
    v_sub_f32 v139, v139, v244
    v_sub_f32 v123, v123, v244
    v_sub_f32 v140, v140, v244
    v_sub_f32 v124, v124, v244
    v_sub_f32 v141, v141, v244
    v_sub_f32 v125, v125, v244
    v_sub_f32 v142, v142, v244
    v_sub_f32 v126, v126, v244
    v_sub_f32 v143, v143, v244
    v_sub_f32 v127, v127, v244
    v_mov_b32 v233, 0
    v_exp_f32 v224, v128
    v_exp_f32 v225, v129
    s_nop 0
    v_add_f32 v233, v233, v224
    v_add_f32 v233, v233, v225
    v_cvt_pk_bf16_f32 v152, v224, v225
    v_exp_f32 v224, v130
    v_exp_f32 v225, v131
    s_nop 0
    v_add_f32 v233, v233, v224
    v_add_f32 v233, v233, v225
    v_cvt_pk_bf16_f32 v153, v224, v225
    v_exp_f32 v224, v132
    v_exp_f32 v225, v133
    s_nop 0
    v_add_f32 v233, v233, v224
    v_add_f32 v233, v233, v225
    v_cvt_pk_bf16_f32 v154, v224, v225
    v_exp_f32 v224, v134
    v_exp_f32 v225, v135
    s_nop 0
    v_add_f32 v233, v233, v224
    v_add_f32 v233, v233, v225
    v_cvt_pk_bf16_f32 v155, v224, v225
    v_exp_f32 v224, v136
    v_exp_f32 v225, v137
    s_nop 0
    v_add_f32 v233, v233, v224
    v_add_f32 v233, v233, v225
    v_cvt_pk_bf16_f32 v156, v224, v225
    v_exp_f32 v224, v138
    v_exp_f32 v225, v139
    s_nop 0
    v_add_f32 v233, v233, v224
    v_add_f32 v233, v233, v225
    v_cvt_pk_bf16_f32 v157, v224, v225
    v_exp_f32 v224, v140
    v_exp_f32 v225, v141
    s_nop 0
    v_add_f32 v233, v233, v224
    v_add_f32 v233, v233, v225
    v_cvt_pk_bf16_f32 v158, v224, v225
    v_exp_f32 v224, v142
    v_exp_f32 v225, v143
    s_nop 0
    v_add_f32 v233, v233, v224
    v_add_f32 v233, v233, v225
    v_cvt_pk_bf16_f32 v159, v224, v225
    s_nop 3
    s_cmp_eq_u32 s62, 0
    s_cbranch_scc1 L_ret0
    s_cmp_eq_u32 s62, 22
    s_cbranch_scc1 L_ret22
    s_cmp_eq_u32 s62, 20
    s_cbranch_scc1 L_ret20
    s_cmp_eq_u32 s62, 10
    s_cbranch_scc1 L_ret10
    s_cmp_eq_u32 s62, 12
    s_cbranch_scc1 L_ret12
    s_branch L_ret14

L_rt_e1:
    s_mov_b32 s61, 0x40000
L_rl_e1:
    buffer_load_dword v145, v233, s[40:43], s45 offen sc1
    s_waitcnt vmcnt(0)
    v_readlane_b32 s51, v145, 1
    s_nop 0
    s_cmp_eq_u32 s51, s100
    s_cbranch_scc1 L_ok_e1
    s_sub_u32 s61, s61, 1
    s_cmp_lg_u32 s61, 0
    s_cbranch_scc1 L_rl_e1
    s_branch L_ok_e1

L_rt_e2:
    s_mov_b32 s61, 0x40000
L_rl_e2:
    buffer_load_dword v145, v233, s[40:43], s45 offen sc1
    s_waitcnt vmcnt(0)
    v_readlane_b32 s51, v145, 2
    s_nop 0
    s_cmp_eq_u32 s51, s100
    s_cbranch_scc1 L_ok_e2
    s_sub_u32 s61, s61, 1
    s_cmp_lg_u32 s61, 0
    s_cbranch_scc1 L_rl_e2
    s_branch L_ok_e2

L_rt_e3:
    s_mov_b32 s61, 0x40000
L_rl_e3:
    buffer_load_dword v145, v233, s[40:43], s45 offen sc1
    s_waitcnt vmcnt(0)
    v_readlane_b32 s51, v145, 3
    s_nop 0
    s_cmp_eq_u32 s51, s100
    s_cbranch_scc1 L_ok_e3
    s_sub_u32 s61, s61, 1
    s_cmp_lg_u32 s61, 0
    s_cbranch_scc1 L_rl_e3
    s_branch L_ok_e3

.section .rodata,"a"
.p2align 6
.amdhsa_kernel standalone__gqa_block_cached__near_ridge_kernel
  .amdhsa_next_free_vgpr 256
  .amdhsa_next_free_sgpr 102
  .amdhsa_accum_offset 256
  .amdhsa_group_segment_fixed_size 0
  .amdhsa_kernarg_size 64
  .amdhsa_user_sgpr_count 2
  .amdhsa_user_sgpr_kernarg_segment_ptr 1
  .amdhsa_system_sgpr_workgroup_id_x 1
.end_amdhsa_kernel
```
